```python
import torch

def _softmax(x, axis=-1):
    return torch.softmax(x, dim=axis)

def _gelu(x):
    return torch.nn.functional.gelu(x, approximate='tanh')

def _silu(x):
    return torch.nn.functional.silu(x)

def _sigmoid(x):
    return torch.sigmoid(x)

def _layernorm(x, axis=-1, eps=1e-05):
    m = x.mean(dim=axis, keepdim=True)
    v = x.var(dim=axis, keepdim=True, unbiased=False)
    return (x - m) / torch.sqrt(v + eps)

def _scatter_add(tgt, idx, src, axis=0):
    return tgt.clone().index_add_(axis, idx, src)

def _segment_sum(src, seg, n):
    out = torch.zeros((n,) + src.shape[1:], dtype=src.dtype)
    return out.index_add_(0, seg, src)

def _pad(x, pw):
    flat = tuple((v for pair in reversed(pw) for v in pair))
    return torch.nn.functional.pad(x, flat)
kernel_name = 'gather_scatter__tensor_product_equiv_equiformer__graph'

def setup_inputs():

    _w = lambda a: (lambda t: t.to(torch.bfloat16) if t.is_floating_point() else t)(torch.as_tensor(a))
    N, deg, C, De = (25000, 32, 64, max(0, 1))
    E = N * deg
    src = (lambda lo, hi, *s: torch.randint(lo, hi, s))(0, N, E).to(torch.int64)
    dst = (lambda lo, hi, *s: torch.randint(lo, hi, s))(0, N, E).to(torch.int64)
    rvec = (lambda *s: torch.randn(*s, dtype=torch.bfloat16) * 0.05)(E, 3).to(float)
    rn = (torch.linalg.norm(rvec, dim=-1, keepdim=True) + 1e-06).to(float)
    rhat = (rvec / rn).to(float)
    eps = torch.zeros((3, 3, 3), dtype=float)
    eps[0, 1, 2] = eps[1, 2, 0] = eps[2, 0, 1] = 1.0
    eps[0, 2, 1] = eps[2, 1, 0] = eps[1, 0, 2] = -1.0
    return {'x': _w((lambda *s: torch.randn(*s, dtype=torch.bfloat16) * 0.4)(N, 4 * C).to(float)), 'rhat': _w(rhat), 'e_attr': _w((lambda *s: torch.randn(*s, dtype=torch.bfloat16) * 0.4)(E, De).to(float)), 'src': _w(src), 'dst': _w(dst), 'w_rad': _w((lambda *s: torch.randn(*s, dtype=torch.bfloat16) * 0.4)(De, 5 * C).to(float)), 'w_si0': _w((lambda *s: torch.randn(*s, dtype=torch.bfloat16) * 0.4)(2 * C, C).to(float)), 'w_si1': _w((lambda *s: torch.randn(*s, dtype=torch.bfloat16) * 0.05)(3 * C, C).to(float)), 'cg_eps': _w(eps)}

def reference(x, rhat, e_attr, src, dst, w_rad, w_si0, w_si1, cg_eps):
    N = x.shape[0]
    C = w_si0.shape[1]
    E = rhat.shape[0]
    x0 = x[:, :C].clone()
    x1 = x[:, C:].reshape(N, 3, C)
    R = (e_attr @ w_rad).reshape(E, 5, C)
    f0 = x0[src]
    f1 = x1[src]
    Y1 = rhat
    p00_0 = f0 * R[:, 0, :]
    p11_0 = torch.einsum('ejc,ej->ec', f1, Y1) * R[:, 1, :]
    p01_1 = torch.einsum('ec,ej->ejc', f0, Y1) * R[:, 2, :][:, None, :]
    p10_1 = f1 * R[:, 3, :][:, None, :]
    p11_1 = torch.einsum('ijk,ekc,ej->eic', cg_eps, f1, Y1) * R[:, 4, :][:, None, :]
    m0 = torch.concatenate([p00_0, p11_0], axis=-1) @ w_si0
    m1 = torch.einsum('ejp,pc->ejc', torch.concatenate([p01_1, p10_1, p11_1], axis=-1), w_si1)
    agg0 = _segment_sum(m0, dst, N)
    agg1 = _segment_sum(m1.reshape(E, 3 * C), dst, N).reshape(N, 3, C)
    gate = _sigmoid(agg0)
    out1 = agg1 * gate[:, None, :]
    return torch.concatenate([agg0, out1.reshape(N, 3 * C)], axis=-1)
```

```asm
; @launch kernel=sort_kernel grid=(256,1,1) block=(832,1,1) lds=53248
; @launch kernel=main_kernel grid=(256,1,1) block=(256,1,1) lds=162880
.amdgcn_target "amdgcn-amd-amdhsa--gfx950"
.text
.globl sort_kernel
.p2align 8
.type sort_kernel,@function
sort_kernel:
    s_cmp_ge_u32 s2, 256
    s_cbranch_scc1 L_k1_end
    s_load_dwordx4 s[4:7], s[0:1], 0
    s_load_dwordx4 s[8:11], s[0:1], 16
    s_load_dwordx4 s[12:15], s[0:1], 32
    s_load_dwordx4 s[16:19], s[0:1], 48
    s_load_dwordx2 s[20:21], s[0:1], 88
    s_and_b32 s22, s2, 7
    s_lshl_b32 s22, s22, 5
    s_lshr_b32 s23, s2, 3
    s_add_u32 s22, s22, s23
    v_lshlrev_b32 v1, 4, v0
    v_mul_u32_u24 v2, 24, v0
    v_lshlrev_b32 v3, 3, v0
    s_lshl_b32 s60, s22, 2
    s_add_u32 s60, s60, 9600000
    s_cmp_ge_u32 s22, 250
    s_cbranch_scc1 L_k1_wprep
    s_mul_i32 s56, s22, 12800
    s_mul_i32 s57, s22, 19200
    s_mul_i32 s58, s22, 6400
    s_mul_i32 s48, s22, 51200
    v_cmp_gt_u32 vcc, 800, v0
    s_and_b64 exec, exec, vcc
    v_mov_b32 v44, 0
    v_mov_b32 v45, 0
    v_mov_b32 v46, 0
    v_mov_b32 v47, 0
    v_readfirstlane_b32 s61, v0
    s_cmp_lt_u32 s61, 64
    s_cbranch_scc0 L_k1_nz
    ds_write_b128 v1, v[44:47] offset:0
L_k1_nz:
    s_mov_b32 s62, 43980466
    s_mov_b32 s63, 3125
    s_mov_b32 s64, 0xc0000000
    s_mov_b32 s65, 786432
    v_mov_b32 v50, 1
    v_lshlrev_b32 v60, 12, v0
    s_waitcnt lgkmcnt(0)
    s_mov_b32 s24, s12
    s_mov_b32 s25, s13
    s_mov_b32 s26, 3200000
    s_mov_b32 s27, 0x20000
    buffer_load_dwordx4 v[4:7], v1, s[24:27], s56 offen
    s_mov_b32 s28, s10
    s_mov_b32 s29, s11
    s_mov_b32 s30, 3200000
    s_mov_b32 s31, 0x20000
    s_mov_b32 s32, s6
    s_mov_b32 s33, s7
    s_mov_b32 s34, 4800000
    s_mov_b32 s35, 0x20000
    s_mov_b32 s36, s8
    s_mov_b32 s37, s9
    s_mov_b32 s38, 1600000
    s_mov_b32 s39, 0x20000
    s_barrier
    buffer_load_dwordx4 v[8:11], v1, s[28:31], s56 offen
    buffer_load_dwordx4 v[12:15], v2, s[32:35], s57 offen
    buffer_load_dwordx2 v[16:17], v2, s[32:35], s57 offen offset:16
    buffer_load_dwordx2 v[18:19], v3, s[36:39], s58 offen
    s_mov_b32 s44, s20
    s_mov_b32 s45, s21
    s_mov_b32 s46, 9911296
    s_mov_b32 s47, 0x20000
    s_waitcnt vmcnt(4)
    v_mul_hi_u32 v52, v4, s62
    v_mul_hi_u32 v53, v5, s62
    v_mul_hi_u32 v54, v6, s62
    v_mul_hi_u32 v55, v7, s62
    v_lshlrev_b32 v20, 2, v52
    ds_add_rtn_u32 v24, v20, v50 offset:0
    v_lshlrev_b32 v21, 2, v53
    ds_add_rtn_u32 v25, v21, v50 offset:0
    v_lshlrev_b32 v22, 2, v54
    ds_add_rtn_u32 v26, v22, v50 offset:0
    v_lshlrev_b32 v23, 2, v55
    ds_add_rtn_u32 v27, v23, v50 offset:0
    v_mad_u32_u24 v52, v52, s63, 31
    v_mad_u32_u24 v53, v53, s63, 31
    v_mad_u32_u24 v54, v54, s63, 31
    v_mad_u32_u24 v55, v55, s63, 31
    v_lshrrev_b32 v52, 5, v52
    v_lshrrev_b32 v53, 5, v53
    v_lshrrev_b32 v54, 5, v54
    v_lshrrev_b32 v55, 5, v55
    v_sub_u32 v4, v4, v52
    v_sub_u32 v5, v5, v53
    v_sub_u32 v6, v6, v54
    v_sub_u32 v7, v7, v55
    s_waitcnt lgkmcnt(0)
    s_barrier
    s_cmp_lt_u32 s61, 64
    s_cbranch_scc0 L_k1_ns
    ds_read_b128 v[52:55], v1 offset:0
    s_waitcnt lgkmcnt(0)
    v_add_u32 v56, v52, v53
    v_add_u32 v57, v56, v54
    v_add_u32 v58, v57, v55
    v_mov_b32 v59, v58
    s_nop 1
    v_add_u32_dpp v59, v59, v59 row_shr:1 row_mask:0xf bank_mask:0xf
    s_nop 1
    v_add_u32_dpp v59, v59, v59 row_shr:2 row_mask:0xf bank_mask:0xf
    s_nop 1
    v_add_u32_dpp v59, v59, v59 row_shr:4 row_mask:0xf bank_mask:0xf
    s_nop 1
    v_add_u32_dpp v59, v59, v59 row_shr:8 row_mask:0xf bank_mask:0xf
    s_nop 1
    v_add_u32_dpp v59, v59, v59 row_bcast:15 row_mask:0xa bank_mask:0xf
    s_nop 1
    v_add_u32_dpp v59, v59, v59 row_bcast:31 row_mask:0xc bank_mask:0xf
    v_sub_u32 v44, v59, v58
    v_add_u32 v45, v44, v52
    v_add_u32 v46, v44, v56
    v_add_u32 v47, v44, v57
    ds_write_b128 v1, v[44:47] offset:1024
    v_lshl_or_b32 v64, v52, 16, v44
    v_lshl_or_b32 v65, v53, 16, v45
    v_lshl_or_b32 v66, v54, 16, v46
    v_lshl_or_b32 v67, v55, 16, v47
    s_waitcnt lgkmcnt(0)
L_k1_ns:
    s_barrier
    ds_read_b32 v44, v20 offset:1024
    ds_read_b32 v45, v21 offset:1024
    ds_read_b32 v46, v22 offset:1024
    ds_read_b32 v47, v23 offset:1024
    s_mul_i32 s56, s22, 12800
    s_lshl_b32 s68, s56, 1
    s_add_u32 s68, s68, 3200000
    s_add_u32 s57, s56, 3200
    s_add_u32 s69, s68, 6400
    s_add_u32 s58, s56, 6400
    s_add_u32 s70, s68, 12800
    s_add_u32 s59, s56, 9600
    s_add_u32 s71, s68, 19200
    v_lshlrev_b32 v2, 2, v0
    s_waitcnt vmcnt(3)
    v_mul_u32_u24 v56, 0x29f00, v8
    v_lshl_or_b32 v52, v4, 20, v8
    v_mul_u32_u24 v57, 0x29f00, v9
    v_lshl_or_b32 v53, v5, 20, v9
    v_mul_u32_u24 v58, 0x29f00, v10
    v_lshl_or_b32 v54, v6, 20, v10
    v_mul_u32_u24 v59, 0x29f00, v11
    v_lshl_or_b32 v55, v7, 20, v11
    v_lshrrev_b32 v61, 7, v20
    v_lshlrev_b32 v61, 29, v61
    v_sub_u32 v56, v56, v61
    v_lshrrev_b32 v62, 7, v21
    v_lshlrev_b32 v62, 29, v62
    v_sub_u32 v57, v57, v62
    v_lshrrev_b32 v61, 7, v22
    v_lshlrev_b32 v61, 29, v61
    v_sub_u32 v58, v58, v61
    v_lshrrev_b32 v62, 7, v23
    v_lshlrev_b32 v62, 29, v62
    v_sub_u32 v59, v59, v62
    v_and_or_b32 v52, v56, s64, v52
    v_lshrrev_b32 v56, 10, v56
    v_and_or_b32 v53, v57, s64, v53
    v_lshrrev_b32 v57, 10, v57
    v_and_or_b32 v54, v58, s64, v54
    v_lshrrev_b32 v58, 10, v58
    v_and_or_b32 v55, v59, s64, v55
    v_lshrrev_b32 v59, 10, v59
    v_and_or_b32 v30, v56, s65, v52
    v_and_or_b32 v34, v57, s65, v53
    v_and_or_b32 v38, v58, s65, v54
    v_and_or_b32 v42, v59, s65, v55
    s_waitcnt lgkmcnt(0)
    v_add_lshl_u32 v44, v44, v24, 2
    ds_write_b32 v44, v30 offset:27648
    v_lshlrev_b32 v44, 1, v44
    v_add_lshl_u32 v45, v45, v25, 2
    ds_write_b32 v45, v34 offset:27648
    v_lshlrev_b32 v45, 1, v45
    v_add_lshl_u32 v46, v46, v26, 2
    ds_write_b32 v46, v38 offset:27648
    v_lshlrev_b32 v46, 1, v46
    v_add_lshl_u32 v47, v47, v27, 2
    ds_write_b32 v47, v42 offset:27648
    v_lshlrev_b32 v47, 1, v47
    s_waitcnt vmcnt(0)
    v_lshlrev_b32 v52, 16, v18
    v_lshlrev_b32 v53, 16, v12
    v_and_b32 v54, 0xffff0000, v12
    v_lshlrev_b32 v55, 16, v13
    v_mul_f32 v53, v52, v53
    v_mul_f32 v54, v52, v54
    v_mul_f32 v55, v52, v55
    v_cvt_pk_bf16_f32 v28, v52, v53
    v_cvt_pk_bf16_f32 v29, v54, v55
    ds_write_b64 v44, v[28:29] offset:2048
    v_and_b32 v52, 0xffff0000, v18
    v_and_b32 v53, 0xffff0000, v13
    v_lshlrev_b32 v54, 16, v14
    v_and_b32 v55, 0xffff0000, v14
    v_mul_f32 v53, v52, v53
    v_mul_f32 v54, v52, v54
    v_mul_f32 v55, v52, v55
    v_cvt_pk_bf16_f32 v32, v52, v53
    v_cvt_pk_bf16_f32 v33, v54, v55
    ds_write_b64 v45, v[32:33] offset:2048
    v_lshlrev_b32 v52, 16, v19
    v_lshlrev_b32 v53, 16, v15
    v_and_b32 v54, 0xffff0000, v15
    v_lshlrev_b32 v55, 16, v16
    v_mul_f32 v53, v52, v53
    v_mul_f32 v54, v52, v54
    v_mul_f32 v55, v52, v55
    v_cvt_pk_bf16_f32 v36, v52, v53
    v_cvt_pk_bf16_f32 v37, v54, v55
    ds_write_b64 v46, v[36:37] offset:2048
    v_and_b32 v52, 0xffff0000, v19
    v_and_b32 v53, 0xffff0000, v16
    v_lshlrev_b32 v54, 16, v17
    v_and_b32 v55, 0xffff0000, v17
    v_mul_f32 v53, v52, v53
    v_mul_f32 v54, v52, v54
    v_mul_f32 v55, v52, v55
    v_cvt_pk_bf16_f32 v40, v52, v53
    v_cvt_pk_bf16_f32 v41, v54, v55
    ds_write_b64 v47, v[40:41] offset:2048
    s_waitcnt lgkmcnt(0)
    s_barrier
    ds_read_b128 v[8:11], v1 offset:2048
    ds_read_b128 v[12:15], v1 offset:14848
    ds_read_b128 v[4:7], v1 offset:27648
    s_add_u32 s69, s68, 12800
    s_waitcnt lgkmcnt(2)
    buffer_store_dwordx4 v[8:11], v1, s[44:47], s68 offen sc1
    s_waitcnt lgkmcnt(1)
    buffer_store_dwordx4 v[12:15], v1, s[44:47], s69 offen sc1
    s_waitcnt lgkmcnt(0)
    buffer_store_dwordx4 v[4:7], v1, s[44:47], s56 offen sc1
    s_cmp_lt_u32 s61, 64
    s_cbranch_scc0 L_k1_notab
    buffer_store_dword v64, v60, s[44:47], s60 offen offset:0
    buffer_store_dword v65, v60, s[44:47], s60 offen offset:1024
    buffer_store_dword v66, v60, s[44:47], s60 offen offset:2048
    buffer_store_dword v67, v60, s[44:47], s60 offen offset:3072
L_k1_notab:
    s_endpgm
L_k1_wprep:
    v_cmp_gt_u32 vcc, 512, v0
    s_and_b64 exec, exec, vcc
    s_cbranch_execz L_k1_end
    s_sub_u32 s23, s22, 250
    s_min_u32 s24, s23, 4
    s_lshl_b32 s24, s24, 7
    s_and_b32 s25, s23, 1
    s_lshl_b32 s25, s25, 13
    s_cmp_ge_u32 s23, 4
    s_cselect_b32 s25, 16384, s25
    s_cmp_eq_u32 s23, 5
    s_cselect_b32 s26, 0x80000000, 0
    s_lshl_b32 s27, s23, 13
    s_add_u32 s27, s27, 9862144
    v_lshrrev_b32 v4, 6, v0
    v_and_b32 v5, 63, v0
    v_and_b32 v6, 31, v5
    v_lshrrev_b32 v7, 5, v5
    v_and_b32 v8, 1, v4
    v_lshl_add_u32 v6, v6, 1, v8
    v_bfe_u32 v8, v4, 1, 1
    v_lshl_add_u32 v7, v8, 1, v7
    v_lshrrev_b32 v8, 2, v4
    v_lshlrev_b32 v8, 2, v8
    v_lshl_add_u32 v7, v7, 4, v8
    v_lshlrev_b32 v9, 1, v7
    v_lshlrev_b32 v10, 6, v7
    v_add_lshl_u32 v10, v10, v6, 1
    v_mov_b32 v11, 0
    v_lshlrev_b32 v30, 10, v0
    s_waitcnt lgkmcnt(0)
    s_mov_b32 s44, s20
    s_mov_b32 s45, s21
    s_mov_b32 s46, 9911296
    s_mov_b32 s47, 0x20000
    s_mov_b32 s32, s14
    s_mov_b32 s33, s15
    s_mov_b32 s34, 640
    s_mov_b32 s35, 0x20000
    s_mov_b32 s36, s16
    s_mov_b32 s37, s17
    s_mov_b32 s38, 16384
    s_mov_b32 s39, 0x20000
    s_mov_b32 s40, s18
    s_mov_b32 s41, s19
    s_mov_b32 s42, 24576
    s_mov_b32 s43, 0x20000
    buffer_load_dwordx2 v[12:13], v9, s[32:35], s24 offen
    buffer_load_dwordx2 v[14:15], v9, s[32:35], s24 offen offset:16
    s_cmp_ge_u32 s23, 2
    s_cbranch_scc1 L_k1_w1
    buffer_load_ushort v16, v10, s[36:39], s25 offen offset:0
    buffer_load_ushort v17, v10, s[36:39], s25 offen offset:128
    buffer_load_ushort v18, v10, s[36:39], s25 offen offset:256
    buffer_load_ushort v19, v10, s[36:39], s25 offen offset:384
    buffer_load_ushort v20, v10, s[36:39], s25 offen offset:1024
    buffer_load_ushort v21, v10, s[36:39], s25 offen offset:1152
    buffer_load_ushort v22, v10, s[36:39], s25 offen offset:1280
    buffer_load_ushort v23, v10, s[36:39], s25 offen offset:1408
    s_branch L_k1_w2
L_k1_w1:
    buffer_load_ushort v16, v10, s[40:43], s25 offen offset:0
    buffer_load_ushort v17, v10, s[40:43], s25 offen offset:128
    buffer_load_ushort v18, v10, s[40:43], s25 offen offset:256
    buffer_load_ushort v19, v10, s[40:43], s25 offen offset:384
    buffer_load_ushort v20, v10, s[40:43], s25 offen offset:1024
    buffer_load_ushort v21, v10, s[40:43], s25 offen offset:1152
    buffer_load_ushort v22, v10, s[40:43], s25 offen offset:1280
    buffer_load_ushort v23, v10, s[40:43], s25 offen offset:1408
L_k1_w2:
    v_cmp_gt_u32 vcc, 256, v0
    s_and_saveexec_b64 s[28:29], vcc
    s_cbranch_execz L_k1_w3
    buffer_store_dword v11, v30, s[44:47], s60 offen
L_k1_w3:
    s_mov_b64 exec, s[28:29]
    s_waitcnt vmcnt(0)
    v_lshlrev_b32 v24, 16, v12
    v_lshlrev_b32 v16, 16, v16
    v_mul_f32 v16, v24, v16
    v_xor_b32 v16, s26, v16
    v_and_b32 v24, 0xffff0000, v12
    v_lshlrev_b32 v17, 16, v17
    v_mul_f32 v17, v24, v17
    v_xor_b32 v17, s26, v17
    v_lshlrev_b32 v24, 16, v13
    v_lshlrev_b32 v18, 16, v18
    v_mul_f32 v18, v24, v18
    v_xor_b32 v18, s26, v18
    v_and_b32 v24, 0xffff0000, v13
    v_lshlrev_b32 v19, 16, v19
    v_mul_f32 v19, v24, v19
    v_xor_b32 v19, s26, v19
    v_lshlrev_b32 v24, 16, v14
    v_lshlrev_b32 v20, 16, v20
    v_mul_f32 v20, v24, v20
    v_xor_b32 v20, s26, v20
    v_and_b32 v24, 0xffff0000, v14
    v_lshlrev_b32 v21, 16, v21
    v_mul_f32 v21, v24, v21
    v_xor_b32 v21, s26, v21
    v_lshlrev_b32 v24, 16, v15
    v_lshlrev_b32 v22, 16, v22
    v_mul_f32 v22, v24, v22
    v_xor_b32 v22, s26, v22
    v_and_b32 v24, 0xffff0000, v15
    v_lshlrev_b32 v23, 16, v23
    v_mul_f32 v23, v24, v23
    v_xor_b32 v23, s26, v23
    v_cvt_pk_bf16_f32 v24, v16, v17
    v_cvt_pk_bf16_f32 v25, v18, v19
    v_cvt_pk_bf16_f32 v26, v20, v21
    v_cvt_pk_bf16_f32 v27, v22, v23
    buffer_store_dwordx4 v[24:27], v1, s[44:47], s27 offen
L_k1_end:
    s_endpgm
.globl main_kernel
.p2align 8
.type main_kernel,@function
main_kernel:
    s_cmp_ge_u32 s2, 256
    s_cbranch_scc1 L_k2_end
    s_load_dwordx2 s[4:5], s[0:1], 0
    s_load_dwordx2 s[8:9], s[0:1], 88
    s_load_dwordx2 s[12:13], s[0:1], 72
    v_mov_b32 v35, v0
    v_lshrrev_b32 v1, 6, v0
    v_and_b32 v0, 63, v0
    v_readfirstlane_b32 s16, v1
    s_and_b32 s17, s2, 7
    s_lshl_b32 s17, s17, 5
    s_lshr_b32 s78, s2, 3
    s_add_u32 s17, s17, s78
    s_mul_i32 s18, s17, 3125
    s_add_u32 s19, s18, 3156
    s_add_u32 s18, s18, 31
    s_lshr_b32 s18, s18, 5
    s_lshr_b32 s19, s19, 5
    s_sub_u32 s19, s19, s18
    s_mul_i32 s20, s16, 26064
    s_add_u32 s20, s20, 58624
    s_lshl_b32 s85, s17, 10
    s_add_u32 s85, s85, 9600000
    s_mov_b32 s21, 512
    s_lshr_b32 s89, s17, 5
    s_mul_i32 s89, s89, 1600000
    s_mov_b32 s82, 0
    s_mov_b32 s83, 0
    s_mov_b32 s84, 0
    s_mov_b32 s6, 12800000
    s_mov_b32 s7, 0x20000
    s_mov_b32 s10, 9911296
    s_mov_b32 s11, 0x20000
    s_mov_b32 s14, 12800000
    s_mov_b32 s15, 0x20000
    v_and_b32 v50, 3, v0
    v_cmp_eq_u32 vcc, 3, v50
    v_mov_b32 v58, 0
    v_mov_b32 v59, 0
    v_cndmask_b32 v54, 0, -1, vcc
    v_mov_b32 v55, v54
    v_mov_b32 v56, v54
    v_mov_b32 v57, v54
    v_lshl_add_u32 v51, v0, 4, s20
    v_mov_b32 v60, 0
    v_mov_b32 v61, 0
    v_lshlrev_b32 v52, 4, v35
    ds_write_b128 v52, v[58:61] offset:0
    v_cmp_gt_u32 vcc, 32, v35
    s_and_saveexec_b64 s[78:79], vcc
    ds_write_b128 v52, v[58:61] offset:4096
    s_mov_b64 exec, s[78:79]
    s_mul_i32 s80, s16, 192
    s_mul_i32 s81, s16, 848
    v_lshl_add_u32 v52, v0, 4, s80
    v_lshl_add_u32 v53, v0, 4, s81
    v_mov_b32 v62, 5888
    v_mov_b32 v63, 5888
    v_mov_b32 v64, 5888
    v_mov_b32 v65, 5888
    v_lshlrev_b32 v66, 4, v0
    s_lshl_b32 s80, s16, 7
    v_lshl_add_u32 v67, v0, 2, s80
    v_mov_b32 v68, 2147483632
    v_mov_b32 v43, 0
    s_mov_b64 exec, 0xfff
    ds_write_b128 v52, v[58:61] offset:5120
    s_mov_b32 exec_lo, -1
    s_mov_b32 exec_hi, 0x1fffff
    ds_write_b128 v53, v[62:65] offset:6016
    s_mov_b32 exec_hi, 0
    ds_write_b32 v67, v68 offset:4608
    s_mov_b32 exec_lo, 0xff
    ds_write_b128 v66, v[54:57] offset:5888
    s_mov_b64 exec, -1
    ds_write_b128 v51, v[54:57] offset:0
    ds_write_b128 v51, v[54:57] offset:1024
    ds_write_b128 v51, v[54:57] offset:2048
    ds_write_b128 v51, v[54:57] offset:3072
    ds_write_b128 v51, v[54:57] offset:4096
    ds_write_b128 v51, v[54:57] offset:5136
    ds_write_b128 v51, v[54:57] offset:6160
    ds_write_b128 v51, v[54:57] offset:7184
    v_and_b32 v6, 15, v0
    v_lshrrev_b32 v50, 4, v35
    v_lshlrev_b32 v70, 6, v50
    v_lshlrev_b32 v71, 2, v35
    s_mov_b32 s78, 204800
    v_mul_lo_u32 v7, v50, s78
    v_mad_u32_u24 v7, v6, 4, v7
    v_mov_b32 v12, 0
    v_mov_b32 v13, 0
    v_mov_b32 v14, 0
    v_mov_b32 v15, 0
    s_waitcnt lgkmcnt(0)
    buffer_load_dwordx4 v[240:243], v70, s[8:11], s85 offen offset:0
    buffer_load_dwordx4 v[244:247], v70, s[8:11], s85 offen offset:16
    buffer_load_dwordx4 v[248:251], v70, s[8:11], s85 offen offset:32
    buffer_load_dwordx4 v[252:255], v70, s[8:11], s85 offen offset:48
    buffer_load_dword v39, v71, s[8:11], s85 offen
    ds_write_b128 v51, v[54:57] offset:8208
    v_mfma_f32_32x32x16_bf16 a[240:255], v[12:15], v[12:15], 0
    ds_write_b128 v51, v[54:57] offset:9232
    v_mfma_f32_32x32x16_bf16 a[224:239], v[12:15], v[12:15], 0
    ds_write_b128 v51, v[54:57] offset:10272
    v_mfma_f32_32x32x16_bf16 a[208:223], v[12:15], v[12:15], 0
    ds_write_b128 v51, v[54:57] offset:11296
    v_mfma_f32_32x32x16_bf16 a[192:207], v[12:15], v[12:15], 0
    ds_write_b128 v51, v[54:57] offset:12320
    v_mfma_f32_32x32x16_bf16 a[176:191], v[12:15], v[12:15], 0
    ds_write_b128 v51, v[54:57] offset:13344
    v_mfma_f32_32x32x16_bf16 a[160:175], v[12:15], v[12:15], 0
    ds_write_b128 v51, v[54:57] offset:14368
    v_mfma_f32_32x32x16_bf16 a[144:159], v[12:15], v[12:15], 0
    ds_write_b128 v51, v[54:57] offset:15408
    v_mfma_f32_32x32x16_bf16 a[128:143], v[12:15], v[12:15], 0
    ds_write_b128 v51, v[54:57] offset:16432
    v_mfma_f32_32x32x16_bf16 a[112:127], v[12:15], v[12:15], 0
    ds_write_b128 v51, v[54:57] offset:17456
    v_mfma_f32_32x32x16_bf16 a[96:111], v[12:15], v[12:15], 0
    ds_write_b128 v51, v[54:57] offset:18480
    v_mfma_f32_32x32x16_bf16 a[80:95], v[12:15], v[12:15], 0
    ds_write_b128 v51, v[54:57] offset:19504
    v_mfma_f32_32x32x16_bf16 a[64:79], v[12:15], v[12:15], 0
    ds_write_b128 v51, v[54:57] offset:20544
    v_mfma_f32_32x32x16_bf16 a[48:63], v[12:15], v[12:15], 0
    ds_write_b128 v51, v[54:57] offset:21568
    v_mfma_f32_32x32x16_bf16 a[32:47], v[12:15], v[12:15], 0
    ds_write_b128 v51, v[54:57] offset:22592
    v_mfma_f32_32x32x16_bf16 a[16:31], v[12:15], v[12:15], 0
    ds_write_b128 v51, v[54:57] offset:23616
    v_mfma_f32_32x32x16_bf16 a[0:15], v[12:15], v[12:15], 0
    ds_write_b128 v51, v[54:57] offset:24640
    v_and_b32 v1, 31, v0
    v_lshrrev_b32 v2, 5, v0
    v_lshrrev_b32 v70, 3, v1
    v_mul_u32_u24 v70, 0x202, v70
    v_add_u32 v70, 0x100, v70
    v_or_b32 v71, 0x0c0c0000, v70
    v_lshlrev_b32 v70, 16, v70
    v_or_b32 v70, 0x0c0c, v70
    v_and_b32 v72, 1, v0
    v_cmp_eq_u32 vcc, 1, v72
    v_bfe_u32 v72, v0, 1, 2
    v_mov_b32 v73, 0x0c0c0c0c
    v_cndmask_b32 v70, v71, v70, vcc
    v_cmp_eq_u32 s[24:25], 0, v72
    v_cmp_eq_u32 s[26:27], 1, v72
    v_cmp_eq_u32 s[28:29], 2, v72
    v_cmp_eq_u32 s[30:31], 3, v72
    v_lshlrev_b32 v1, 4, v1
    v_lshlrev_b32 v2, 6, v2
    v_cndmask_b32 v8, v73, v70, s[24:25]
    v_cndmask_b32 v9, v73, v70, s[26:27]
    v_cndmask_b32 v10, v73, v70, s[28:29]
    v_cndmask_b32 v11, v73, v70, s[30:31]
    s_waitcnt vmcnt(0)
    s_mov_b32 s78, 0
    v_mad_u32_u16 v49, v240, 4, v7
    v_cmpx_lt_u32_sdwa s[34:35], v6, v240 src0_sel:DWORD src1_sel:WORD_1
    buffer_load_dword v46, v49, s[8:11], s78 offen
    s_mov_b64 exec, -1
    s_add_u32 s78, s78, 12800
    v_mad_u32_u16 v117, v241, 4, v7
    v_cmpx_lt_u32_sdwa s[36:37], v6, v241 src0_sel:DWORD src1_sel:WORD_1
    buffer_load_dword v114, v117, s[8:11], s78 offen
    s_mov_b64 exec, -1
    s_add_u32 s78, s78, 12800
    v_mad_u32_u16 v123, v242, 4, v7
    v_cmpx_lt_u32_sdwa s[38:39], v6, v242 src0_sel:DWORD src1_sel:WORD_1
    buffer_load_dword v120, v123, s[8:11], s78 offen
    s_mov_b64 exec, -1
    s_add_u32 s78, s78, 12800
    v_mad_u32_u16 v129, v243, 4, v7
    v_cmpx_lt_u32_sdwa s[40:41], v6, v243 src0_sel:DWORD src1_sel:WORD_1
    buffer_load_dword v126, v129, s[8:11], s78 offen
    s_mov_b64 exec, -1
    s_add_u32 s78, s78, 12800
    v_mad_u32_u16 v135, v244, 4, v7
    v_cmpx_lt_u32_sdwa s[42:43], v6, v244 src0_sel:DWORD src1_sel:WORD_1
    buffer_load_dword v132, v135, s[8:11], s78 offen
    s_mov_b64 exec, -1
    s_add_u32 s78, s78, 12800
    v_mad_u32_u16 v141, v245, 4, v7
    v_cmpx_lt_u32_sdwa s[44:45], v6, v245 src0_sel:DWORD src1_sel:WORD_1
    buffer_load_dword v138, v141, s[8:11], s78 offen
    s_mov_b64 exec, -1
    s_add_u32 s78, s78, 12800
    v_mad_u32_u16 v147, v246, 4, v7
    v_cmpx_lt_u32_sdwa s[46:47], v6, v246 src0_sel:DWORD src1_sel:WORD_1
    buffer_load_dword v144, v147, s[8:11], s78 offen
    s_mov_b64 exec, -1
    s_add_u32 s78, s78, 12800
    v_mad_u32_u16 v153, v247, 4, v7
    v_cmpx_lt_u32_sdwa s[48:49], v6, v247 src0_sel:DWORD src1_sel:WORD_1
    buffer_load_dword v150, v153, s[8:11], s78 offen
    s_mov_b64 exec, -1
    s_add_u32 s78, s78, 12800
    v_mad_u32_u16 v159, v248, 4, v7
    v_cmpx_lt_u32_sdwa s[50:51], v6, v248 src0_sel:DWORD src1_sel:WORD_1
    buffer_load_dword v156, v159, s[8:11], s78 offen
    s_mov_b64 exec, -1
    s_add_u32 s78, s78, 12800
    v_mad_u32_u16 v165, v249, 4, v7
    v_cmpx_lt_u32_sdwa s[52:53], v6, v249 src0_sel:DWORD src1_sel:WORD_1
    buffer_load_dword v162, v165, s[8:11], s78 offen
    s_mov_b64 exec, -1
    s_add_u32 s78, s78, 12800
    v_mad_u32_u16 v171, v250, 4, v7
    v_cmpx_lt_u32_sdwa s[54:55], v6, v250 src0_sel:DWORD src1_sel:WORD_1
    buffer_load_dword v168, v171, s[8:11], s78 offen
    s_mov_b64 exec, -1
    s_add_u32 s78, s78, 12800
    v_mad_u32_u16 v177, v251, 4, v7
    v_cmpx_lt_u32_sdwa s[56:57], v6, v251 src0_sel:DWORD src1_sel:WORD_1
    buffer_load_dword v174, v177, s[8:11], s78 offen
    s_mov_b64 exec, -1
    s_add_u32 s78, s78, 12800
    v_mad_u32_u16 v183, v252, 4, v7
    v_cmpx_lt_u32_sdwa s[58:59], v6, v252 src0_sel:DWORD src1_sel:WORD_1
    buffer_load_dword v180, v183, s[8:11], s78 offen
    s_mov_b64 exec, -1
    s_add_u32 s78, s78, 12800
    v_mad_u32_u16 v189, v253, 4, v7
    v_cmpx_lt_u32_sdwa s[60:61], v6, v253 src0_sel:DWORD src1_sel:WORD_1
    buffer_load_dword v186, v189, s[8:11], s78 offen
    s_mov_b64 exec, -1
    s_add_u32 s78, s78, 12800
    v_mad_u32_u16 v195, v254, 4, v7
    v_cmpx_lt_u32_sdwa s[62:63], v6, v254 src0_sel:DWORD src1_sel:WORD_1
    buffer_load_dword v192, v195, s[8:11], s78 offen
    s_mov_b64 exec, -1
    s_add_u32 s78, s78, 12800
    v_mad_u32_u16 v201, v255, 4, v7
    v_cmpx_lt_u32_sdwa s[64:65], v6, v255 src0_sel:DWORD src1_sel:WORD_1
    buffer_load_dword v198, v201, s[8:11], s78 offen
    s_mov_b64 exec, -1
    v_lshrrev_b32 v50, 16, v39
    v_cmp_lt_u32 s[24:25], 16, v50
    v_cmp_lt_u32 s[26:27], 32, v50
    v_cmp_lt_u32 s[28:29], 48, v50
    s_mov_b32 s78, 12800
    v_mul_lo_u32 v51, v35, s78
    v_mad_u32_u16 v52, v39, 4, v51
    v_mbcnt_lo_u32_b32 v56, s24, 0
    v_mbcnt_hi_u32_b32 v56, s25, v56
    s_bcnt1_i32_b64 s78, s[24:25]
    s_bcnt1_i32_b64 s79, s[26:27]
    s_add_u32 s79, s79, s78
    s_mul_i32 s80, s16, 192
    v_mbcnt_lo_u32_b32 v57, s26, 0
    v_mbcnt_hi_u32_b32 v57, s27, v57
    v_add_u32 v52, 64, v52
    v_add_u32 v53, -16, v50
    v_add_u32 v54, 64, v52
    v_add_u32 v55, -16, v53
    v_add_u32 v57, s78, v57
    v_lshl_add_u32 v56, v56, 3, s80
    v_lshl_add_u32 v57, v57, 3, s80
    v_lshrrev_b32 v58, 4, v0
    v_lshl_add_u32 v58, v58, 3, s80
    s_cmp_gt_u32 s79, 24
    s_cbranch_scc1 L_ov_fail
    s_cmp_lg_u64 s[28:29], 0
    s_cbranch_scc1 L_ov_fail
    s_mov_b64 exec, s[24:25]
    ds_write_b64 v56, v[52:53] offset:5120
    s_mov_b64 exec, s[26:27]
    ds_write_b64 v57, v[54:55] offset:5120
    s_mov_b64 exec, -1
L_ov_done:
    ds_read_b64 v[60:61], v58 offset:5120
    ds_read_b64 v[62:63], v58 offset:5152
    ds_read_b64 v[64:65], v58 offset:5184
    ds_read_b64 v[66:67], v58 offset:5216
    ds_read_b64 v[68:69], v58 offset:5248
    ds_read_b64 v[70:71], v58 offset:5280
    s_waitcnt lgkmcnt(5)
    v_mad_u32_u24 v207, v6, 4, v60
    v_cmpx_lt_u32 s[66:67], v6, v61
    buffer_load_dword v204, v207, s[8:11], 0 offen
    s_mov_b64 exec, -1
    s_waitcnt lgkmcnt(4)
    v_mad_u32_u24 v213, v6, 4, v62
    v_cmpx_lt_u32 s[68:69], v6, v63
    buffer_load_dword v210, v213, s[8:11], 0 offen
    s_mov_b64 exec, -1
    s_waitcnt lgkmcnt(3)
    v_mad_u32_u24 v219, v6, 4, v64
    v_cmpx_lt_u32 s[70:71], v6, v65
    buffer_load_dword v216, v219, s[8:11], 0 offen
    s_mov_b64 exec, -1
    s_waitcnt lgkmcnt(2)
    v_mad_u32_u24 v225, v6, 4, v66
    v_cmpx_lt_u32 s[72:73], v6, v67
    buffer_load_dword v222, v225, s[8:11], 0 offen
    s_mov_b64 exec, -1
    s_waitcnt lgkmcnt(1)
    v_mad_u32_u24 v231, v6, 4, v68
    v_cmpx_lt_u32 s[74:75], v6, v69
    buffer_load_dword v228, v231, s[8:11], 0 offen
    s_mov_b64 exec, -1
    s_waitcnt lgkmcnt(0)
    v_mad_u32_u24 v237, v6, 4, v70
    v_cmpx_lt_u32 s[76:77], v6, v71
    buffer_load_dword v234, v237, s[8:11], 0 offen
    s_mov_b64 exec, -1
    s_waitcnt lgkmcnt(0)
    s_barrier
    v_mov_b32 v80, 1
    s_mov_b32 s78, 3200000
    s_mov_b32 s79, 3200000
    s_mov_b64 exec, s[34:35]
    s_waitcnt vmcnt(21)
    v_lshrrev_b32 v47, 27, v46
    v_bfe_u32 v26, v46, 15, 12
    v_lshlrev_b32 v48, v47, v80
    v_lshlrev_b32 v49, 1, v49
    ds_add_rtn_u32 v48, v26, v48 offset:0
    buffer_load_dwordx2 v[44:45], v49, s[8:11], s78 offen
    s_add_u32 s78, s78, 25600
    s_mov_b64 exec, s[36:37]
    s_waitcnt vmcnt(21)
    v_lshrrev_b32 v115, 27, v114
    v_bfe_u32 v27, v114, 15, 12
    v_lshlrev_b32 v116, v115, v80
    v_lshlrev_b32 v117, 1, v117
    ds_add_rtn_u32 v116, v27, v116 offset:0
    buffer_load_dwordx2 v[112:113], v117, s[8:11], s78 offen
    s_add_u32 s78, s78, 25600
    s_mov_b64 exec, s[38:39]
    s_waitcnt vmcnt(21)
    v_lshrrev_b32 v121, 27, v120
    v_bfe_u32 v26, v120, 15, 12
    v_lshlrev_b32 v122, v121, v80
    v_lshlrev_b32 v123, 1, v123
    ds_add_rtn_u32 v122, v26, v122 offset:0
    buffer_load_dwordx2 v[118:119], v123, s[8:11], s78 offen
    s_add_u32 s78, s78, 25600
    s_mov_b64 exec, s[40:41]
    s_waitcnt vmcnt(21)
    v_lshrrev_b32 v127, 27, v126
    v_bfe_u32 v27, v126, 15, 12
    v_lshlrev_b32 v128, v127, v80
    v_lshlrev_b32 v129, 1, v129
    ds_add_rtn_u32 v128, v27, v128 offset:0
    buffer_load_dwordx2 v[124:125], v129, s[8:11], s78 offen
    s_add_u32 s78, s78, 25600
    s_mov_b64 exec, s[42:43]
    s_waitcnt vmcnt(21)
    v_lshrrev_b32 v133, 27, v132
    v_bfe_u32 v26, v132, 15, 12
    v_lshlrev_b32 v134, v133, v80
    v_lshlrev_b32 v135, 1, v135
    ds_add_rtn_u32 v134, v26, v134 offset:0
    buffer_load_dwordx2 v[130:131], v135, s[8:11], s78 offen
    s_add_u32 s78, s78, 25600
    s_mov_b64 exec, s[44:45]
    s_waitcnt vmcnt(21)
    v_lshrrev_b32 v139, 27, v138
    v_bfe_u32 v27, v138, 15, 12
    v_lshlrev_b32 v140, v139, v80
    v_lshlrev_b32 v141, 1, v141
    ds_add_rtn_u32 v140, v27, v140 offset:0
    buffer_load_dwordx2 v[136:137], v141, s[8:11], s78 offen
    s_add_u32 s78, s78, 25600
    s_mov_b64 exec, s[46:47]
    s_waitcnt vmcnt(21)
    v_lshrrev_b32 v145, 27, v144
    v_bfe_u32 v26, v144, 15, 12
    v_lshlrev_b32 v146, v145, v80
    v_lshlrev_b32 v147, 1, v147
    ds_add_rtn_u32 v146, v26, v146 offset:0
    buffer_load_dwordx2 v[142:143], v147, s[8:11], s78 offen
    s_add_u32 s78, s78, 25600
    s_mov_b64 exec, s[48:49]
    s_waitcnt vmcnt(21)
    v_lshrrev_b32 v151, 27, v150
    v_bfe_u32 v27, v150, 15, 12
    v_lshlrev_b32 v152, v151, v80
    v_lshlrev_b32 v153, 1, v153
    ds_add_rtn_u32 v152, v27, v152 offset:0
    buffer_load_dwordx2 v[148:149], v153, s[8:11], s78 offen
    s_add_u32 s78, s78, 25600
    s_mov_b64 exec, s[50:51]
    s_waitcnt vmcnt(21)
    v_lshrrev_b32 v157, 27, v156
    v_bfe_u32 v26, v156, 15, 12
    v_lshlrev_b32 v158, v157, v80
    v_lshlrev_b32 v159, 1, v159
    ds_add_rtn_u32 v158, v26, v158 offset:0
    buffer_load_dwordx2 v[154:155], v159, s[8:11], s78 offen
    s_add_u32 s78, s78, 25600
    s_mov_b64 exec, s[52:53]
    s_waitcnt vmcnt(21)
    v_lshrrev_b32 v163, 27, v162
    v_bfe_u32 v27, v162, 15, 12
    v_lshlrev_b32 v164, v163, v80
    v_lshlrev_b32 v165, 1, v165
    ds_add_rtn_u32 v164, v27, v164 offset:0
    buffer_load_dwordx2 v[160:161], v165, s[8:11], s78 offen
    s_add_u32 s78, s78, 25600
    s_mov_b64 exec, s[54:55]
    s_waitcnt vmcnt(21)
    v_lshrrev_b32 v169, 27, v168
    v_bfe_u32 v26, v168, 15, 12
    v_lshlrev_b32 v170, v169, v80
    v_lshlrev_b32 v171, 1, v171
    ds_add_rtn_u32 v170, v26, v170 offset:0
    buffer_load_dwordx2 v[166:167], v171, s[8:11], s78 offen
    s_add_u32 s78, s78, 25600
    s_mov_b64 exec, s[56:57]
    s_waitcnt vmcnt(21)
    v_lshrrev_b32 v175, 27, v174
    v_bfe_u32 v27, v174, 15, 12
    v_lshlrev_b32 v176, v175, v80
    v_lshlrev_b32 v177, 1, v177
    ds_add_rtn_u32 v176, v27, v176 offset:0
    buffer_load_dwordx2 v[172:173], v177, s[8:11], s78 offen
    s_add_u32 s78, s78, 25600
    s_mov_b64 exec, s[58:59]
    s_waitcnt vmcnt(21)
    v_lshrrev_b32 v181, 27, v180
    v_bfe_u32 v26, v180, 15, 12
    v_lshlrev_b32 v182, v181, v80
    v_lshlrev_b32 v183, 1, v183
    ds_add_rtn_u32 v182, v26, v182 offset:0
    buffer_load_dwordx2 v[178:179], v183, s[8:11], s78 offen
    s_add_u32 s78, s78, 25600
    s_mov_b64 exec, s[60:61]
    s_waitcnt vmcnt(21)
    v_lshrrev_b32 v187, 27, v186
    v_bfe_u32 v27, v186, 15, 12
    v_lshlrev_b32 v188, v187, v80
    v_lshlrev_b32 v189, 1, v189
    ds_add_rtn_u32 v188, v27, v188 offset:0
    buffer_load_dwordx2 v[184:185], v189, s[8:11], s78 offen
    s_add_u32 s78, s78, 25600
    s_mov_b64 exec, s[62:63]
    s_waitcnt vmcnt(21)
    v_lshrrev_b32 v193, 27, v192
    v_bfe_u32 v26, v192, 15, 12
    v_lshlrev_b32 v194, v193, v80
    v_lshlrev_b32 v195, 1, v195
    ds_add_rtn_u32 v194, v26, v194 offset:0
    buffer_load_dwordx2 v[190:191], v195, s[8:11], s78 offen
    s_add_u32 s78, s78, 25600
    s_mov_b64 exec, s[64:65]
    s_waitcnt vmcnt(21)
    v_lshrrev_b32 v199, 27, v198
    v_bfe_u32 v27, v198, 15, 12
    v_lshlrev_b32 v200, v199, v80
    v_lshlrev_b32 v201, 1, v201
    ds_add_rtn_u32 v200, v27, v200 offset:0
    buffer_load_dwordx2 v[196:197], v201, s[8:11], s78 offen
    s_and_b32 s3, s17, 31
    s_lshl_b32 s3, s3, 2
    s_add_u32 s3, s3, s16
    s_mul_i32 s3, s3, 1536
    s_add_u32 s3, s3, s89
    s_mov_b64 exec, -1
    v_lshlrev_b32 v111, 7, v0
    s_mov_b32 exec_lo, 0xfff
    s_mov_b32 exec_hi, 0x0
    buffer_load_dword v31, v111, s[4:7], s3 offen
    s_mov_b64 exec, s[66:67]
    s_waitcnt vmcnt(22)
    v_lshrrev_b32 v205, 27, v204
    v_bfe_u32 v26, v204, 15, 12
    v_lshlrev_b32 v206, v205, v80
    v_lshlrev_b32 v207, 1, v207
    ds_add_rtn_u32 v206, v26, v206 offset:0
    buffer_load_dwordx2 v[202:203], v207, s[8:11], s79 offen
    s_mov_b64 exec, s[68:69]
    s_waitcnt vmcnt(22)
    v_lshrrev_b32 v211, 27, v210
    v_bfe_u32 v27, v210, 15, 12
    v_lshlrev_b32 v212, v211, v80
    v_lshlrev_b32 v213, 1, v213
    ds_add_rtn_u32 v212, v27, v212 offset:0
    buffer_load_dwordx2 v[208:209], v213, s[8:11], s79 offen
    s_mov_b64 exec, s[70:71]
    s_waitcnt vmcnt(22)
    v_lshrrev_b32 v217, 27, v216
    v_bfe_u32 v26, v216, 15, 12
    v_lshlrev_b32 v218, v217, v80
    v_lshlrev_b32 v219, 1, v219
    ds_add_rtn_u32 v218, v26, v218 offset:0
    buffer_load_dwordx2 v[214:215], v219, s[8:11], s79 offen
    s_mov_b64 exec, s[72:73]
    s_waitcnt vmcnt(22)
    v_lshrrev_b32 v223, 27, v222
    v_bfe_u32 v27, v222, 15, 12
    v_lshlrev_b32 v224, v223, v80
    v_lshlrev_b32 v225, 1, v225
    ds_add_rtn_u32 v224, v27, v224 offset:0
    buffer_load_dwordx2 v[220:221], v225, s[8:11], s79 offen
    s_mov_b64 exec, s[74:75]
    s_waitcnt vmcnt(22)
    v_lshrrev_b32 v229, 27, v228
    v_bfe_u32 v26, v228, 15, 12
    v_lshlrev_b32 v230, v229, v80
    v_lshlrev_b32 v231, 1, v231
    ds_add_rtn_u32 v230, v26, v230 offset:0
    buffer_load_dwordx2 v[226:227], v231, s[8:11], s79 offen
    s_mov_b64 exec, s[76:77]
    s_waitcnt vmcnt(22)
    v_lshrrev_b32 v235, 27, v234
    v_bfe_u32 v27, v234, 15, 12
    v_lshlrev_b32 v236, v235, v80
    v_lshlrev_b32 v237, 1, v237
    ds_add_rtn_u32 v236, v27, v236 offset:0
    buffer_load_dwordx2 v[232:233], v237, s[8:11], s79 offen
    s_and_b32 s3, s17, 31
    s_lshl_b32 s3, s3, 2
    s_add_u32 s3, s3, s16
    s_mul_i32 s3, s3, 1536
    s_add_u32 s3, s3, s89
    s_add_u32 s3, s3, 196608
    s_mov_b32 exec_lo, 0xfff
    s_mov_b32 exec_hi, 0x0
    buffer_load_dword v31, v111, s[4:7], s3 offen
L_a_done:
    s_mov_b64 exec, -1
    s_waitcnt lgkmcnt(0)
    s_barrier
    s_cmp_eq_u32 s16, 0
    s_cbranch_scc1 L_node
    s_cmp_eq_u32 s82, 0
    s_cbranch_scc0 L_node_wait
    s_sub_u32 s80, s16, 1
    v_lshlrev_b32 v50, 4, v0
    s_lshl_b32 s78, s80, 14
    s_add_u32 s79, s78, 9862144
    s_add_u32 s78, s78, 9472
    s_mov_b32 m0, s78
    s_add_u32 s78, s78, 4096
    buffer_load_dwordx4 v50, s[8:11], s79 offen offset:0 lds
    buffer_load_dwordx4 v50, s[8:11], s79 offen offset:1024 lds
    buffer_load_dwordx4 v50, s[8:11], s79 offen offset:2048 lds
    buffer_load_dwordx4 v50, s[8:11], s79 offen offset:3072 lds
    s_add_u32 s79, s79, 4096
    s_mov_b32 m0, s78
    s_add_u32 s78, s78, 4096
    buffer_load_dwordx4 v50, s[8:11], s79 offen offset:0 lds
    buffer_load_dwordx4 v50, s[8:11], s79 offen offset:1024 lds
    buffer_load_dwordx4 v50, s[8:11], s79 offen offset:2048 lds
    buffer_load_dwordx4 v50, s[8:11], s79 offen offset:3072 lds
    s_add_u32 s79, s79, 4096
    s_mov_b32 m0, s78
    s_add_u32 s78, s78, 4096
    buffer_load_dwordx4 v50, s[8:11], s79 offen offset:0 lds
    buffer_load_dwordx4 v50, s[8:11], s79 offen offset:1024 lds
    buffer_load_dwordx4 v50, s[8:11], s79 offen offset:2048 lds
    buffer_load_dwordx4 v50, s[8:11], s79 offen offset:3072 lds
    s_add_u32 s79, s79, 4096
    s_mov_b32 m0, s78
    s_add_u32 s78, s78, 4096
    buffer_load_dwordx4 v50, s[8:11], s79 offen offset:0 lds
    buffer_load_dwordx4 v50, s[8:11], s79 offen offset:1024 lds
    buffer_load_dwordx4 v50, s[8:11], s79 offen offset:2048 lds
    buffer_load_dwordx4 v50, s[8:11], s79 offen offset:3072 lds
    s_waitcnt vmcnt(16)
    s_branch L_node_done
L_node:
    v_lshlrev_b32 v102, 5, v0
    ds_read_b128 v[50:53], v102 offset:0
    ds_read_b128 v[54:57], v102 offset:16
    ds_read_b128 v[76:79], v102 offset:2048
    ds_read_b128 v[80:83], v102 offset:2064
    v_mov_b32 v70, v0
    v_add_u32 v96, 64, v0
    s_mov_b32 s78, 0x01010101
    v_mov_b32 v103, 1
    v_mov_b32 v107, 0x3dc
    v_add_u32 v72, s18, v70
    v_cmp_gt_u32 s[24:25], s19, v70
    v_lshlrev_b32 v72, 9, v72
    v_mov_b32 v73, 2147483632
    v_cndmask_b32 v73, v73, v72, s[24:25]
    v_add_u32 v98, s18, v96
    v_cmp_gt_u32 s[26:27], s19, v96
    v_lshlrev_b32 v98, 9, v98
    v_mov_b32 v99, 2147483632
    v_cndmask_b32 v99, v99, v98, s[26:27]
    s_waitcnt lgkmcnt(2)
    v_add3_u32 v71, v50, v52, v54
    v_add_u32 v71, v71, v56
    v_sad_u8 v74, v71, 0, 1
    v_lshrrev_b32 v74, 1, v74
    v_min_u32 v74, 40, v74
    v_sub_u32 v66, 62, v74
    v_cndmask_b32 v66, 63, v66, s[24:25]
    v_lshlrev_b32 v66, 2, v66
    ds_add_rtn_u32 v67, v66, v103 offset:4096
    s_waitcnt lgkmcnt(0)
    v_add3_u32 v97, v76, v78, v80
    v_add_u32 v97, v97, v82
    v_sad_u8 v100, v97, 0, 1
    v_lshrrev_b32 v100, 1, v100
    v_min_u32 v100, 40, v100
    v_sub_u32 v92, 62, v100
    v_cndmask_b32 v92, 63, v92, s[26:27]
    v_lshlrev_b32 v92, 2, v92
    ds_add_rtn_u32 v93, v92, v103 offset:4096
    v_lshlrev_b32 v104, 2, v0
    ds_read_b32 v105, v104 offset:4096
    v_lshlrev_b32 v58, 8, v71
    v_mul_lo_u32 v58, v58, s78
    v_add_u32 v60, v58, v50
    v_add_u32 v62, v60, v52
    v_add_u32 v64, v62, v54
    v_lshlrev_b32 v84, 8, v97
    v_mul_lo_u32 v84, v84, s78
    v_add_u32 v86, v84, v76
    v_add_u32 v88, v86, v78
    v_add_u32 v90, v88, v80
    s_cmp_eq_u32 s82, 0
    s_cbranch_scc1 L_sort
    s_waitcnt lgkmcnt(0)
    v_mov_b32 v67, v70
    v_mov_b32 v93, v96
    s_branch L_sorted
L_sort:
    s_waitcnt lgkmcnt(0)
    v_mov_b32 v106, v105
    s_nop 1
    v_add_u32_dpp v106, v106, v106 row_shr:1 row_mask:0xf bank_mask:0xf
    s_nop 1
    v_add_u32_dpp v106, v106, v106 row_shr:2 row_mask:0xf bank_mask:0xf
    s_nop 1
    v_add_u32_dpp v106, v106, v106 row_shr:4 row_mask:0xf bank_mask:0xf
    s_nop 1
    v_add_u32_dpp v106, v106, v106 row_shr:8 row_mask:0xf bank_mask:0xf
    s_nop 1
    v_add_u32_dpp v106, v106, v106 row_bcast:15 row_mask:0xa bank_mask:0xf
    s_nop 1
    v_add_u32_dpp v106, v106, v106 row_bcast:31 row_mask:0xc bank_mask:0xf
    v_sub_u32 v106, v106, v105
    ds_bpermute_b32 v71, v66, v106
    ds_bpermute_b32 v97, v92, v106
    s_waitcnt lgkmcnt(1)
    v_add_u32 v67, v67, v71
    s_waitcnt lgkmcnt(0)
    v_add_u32 v93, v93, v97
L_sorted:
    v_cmp_gt_u32 vcc, 100, v67
    v_mul_u32_u24 v68, 205, v67
    v_lshrrev_b32 v68, 10, v68
    v_mul_u32_u24 v71, 5, v68
    v_sub_u32 v67, v67, v71
    v_lshrrev_b32 v72, 1, v68
    v_and_b32 v72, 14, v72
    v_lshrrev_b32 v72, v72, v107
    v_xor_b32 v71, v72, v68
    v_and_b32 v71, 3, v71
    v_lshrrev_b32 v68, 2, v68
    v_lshl_add_u32 v69, v71, 3, v68
    v_lshlrev_b32 v69, 2, v69
    v_mad_u32_u24 v72, v68, 5, v67
    v_lshl_add_u32 v72, v71, 5, v72
    v_lshlrev_b32 v72, 2, v72
    s_mov_b64 exec, vcc
    ds_max_u32 v69, v74 offset:4352
    ds_write_b32 v72, v73 offset:4608
    s_mov_b64 exec, -1
    v_mul_u32_u24 v71, 26064, v71
    v_mul_u32_u24 v68, 5136, v68
    v_lshl_add_u32 v59, v67, 3, v71
    v_mul_u32_u24 v67, 6, v67
    v_add_u32 v59, v59, v68
    v_add_u32 v59, 58624, v59
    v_lshl_or_b32 v59, v67, 24, v59
    v_mov_b32 v61, v59
    v_mov_b32 v63, v59
    v_mov_b32 v65, v59
    ds_write_b128 v102, v[58:61] offset:0
    ds_write_b128 v102, v[62:65] offset:16
    v_cmp_gt_u32 vcc, 100, v93
    v_mul_u32_u24 v94, 205, v93
    v_lshrrev_b32 v94, 10, v94
    v_mul_u32_u24 v97, 5, v94
    v_sub_u32 v93, v93, v97
    v_lshrrev_b32 v98, 1, v94
    v_and_b32 v98, 14, v98
    v_lshrrev_b32 v98, v98, v107
    v_xor_b32 v97, v98, v94
    v_and_b32 v97, 3, v97
    v_lshrrev_b32 v94, 2, v94
    v_lshl_add_u32 v95, v97, 3, v94
    v_lshlrev_b32 v95, 2, v95
    v_mad_u32_u24 v98, v94, 5, v93
    v_lshl_add_u32 v98, v97, 5, v98
    v_lshlrev_b32 v98, 2, v98
    s_mov_b64 exec, vcc
    ds_max_u32 v95, v100 offset:4352
    ds_write_b32 v98, v99 offset:4608
    s_mov_b64 exec, -1
    v_mul_u32_u24 v97, 26064, v97
    v_mul_u32_u24 v94, 5136, v94
    v_lshl_add_u32 v85, v93, 3, v97
    v_mul_u32_u24 v93, 6, v93
    v_add_u32 v85, v85, v94
    v_add_u32 v85, 58624, v85
    v_lshl_or_b32 v85, v93, 24, v85
    v_mov_b32 v87, v85
    v_mov_b32 v89, v85
    v_mov_b32 v91, v85
    ds_write_b128 v102, v[84:87] offset:2048
    ds_write_b128 v102, v[88:91] offset:2064
L_node_wait:
    s_waitcnt vmcnt(0) lgkmcnt(0)
L_node_done:
    s_barrier
    s_lshl_b32 s80, s16, 5
    v_mov_b32 v90, s80
    ds_read_b128 v[82:85], v90 offset:4352
    ds_read_b32 v86, v90 offset:4368
    s_and_b32 s3, s17, 31
    s_lshl_b32 s3, s3, 2
    s_add_u32 s3, s3, s16
    s_mul_i32 s3, s3, 1536
    s_add_u32 s3, s3, s89
    s_add_u32 s3, s3, 393216
    s_mov_b32 exec_lo, 0xfff
    s_mov_b32 exec_hi, 0x0
    buffer_load_dword v31, v111, s[4:7], s3 offen
    s_mov_b64 exec, s[34:35]
    v_bfe_u32 v26, v46, 15, 12
    ds_read_b64 v[50:51], v26 offset:0
    s_mov_b64 exec, s[36:37]
    v_bfe_u32 v27, v114, 15, 12
    ds_read_b64 v[52:53], v27 offset:0
    s_mov_b64 exec, s[38:39]
    v_bfe_u32 v26, v120, 15, 12
    ds_read_b64 v[54:55], v26 offset:0
    s_mov_b64 exec, s[40:41]
    v_bfe_u32 v27, v126, 15, 12
    ds_read_b64 v[56:57], v27 offset:0
    s_mov_b64 exec, s[42:43]
    v_bfe_u32 v26, v132, 15, 12
    ds_read_b64 v[58:59], v26 offset:0
    s_mov_b64 exec, s[34:35]
    s_waitcnt lgkmcnt(4)
    v_add_u32 v70, v50, v48
    v_bfe_u32 v70, v70, v47, 8
    v_lshl_add_u32 v74, v70, 6, v51
    v_max_u32 v43, v43, v70
    v_and_b32 v74, 0xffffff, v74
    v_sub_u32_sdwa v75, v74, v51 dst_sel:DWORD dst_unused:UNUSED_PAD src0_sel:DWORD src1_sel:BYTE_3
    ds_write_b64 v74, v[44:45]
    ds_write_b16 v75, v46 offset:48
    s_cmp_eq_u32 s82, 0
    s_cbranch_scc0 L_s_slow
    s_mov_b64 exec, s[44:45]
    v_bfe_u32 v27, v138, 15, 12
    ds_read_b64 v[50:51], v27 offset:0
    s_mov_b64 exec, s[36:37]
    s_waitcnt lgkmcnt(6)
    v_add_u32 v72, v52, v116
    v_bfe_u32 v72, v72, v115, 8
    v_lshl_add_u32 v76, v72, 6, v53
    v_max_u32 v43, v43, v72
    v_and_b32 v76, 0xffffff, v76
    v_sub_u32_sdwa v77, v76, v53 dst_sel:DWORD dst_unused:UNUSED_PAD src0_sel:DWORD src1_sel:BYTE_3
    ds_write_b64 v76, v[112:113]
    ds_write_b16 v77, v114 offset:48
    s_mov_b64 exec, -1
    v_max3_u32 v90, v82, v83, v84
    v_max3_u32 v82, v90, v85, v86
    v_cvt_f32_u32 v91, v82
    v_readfirstlane_b32 s23, v82
    v_rcp_f32 v91, v91
    s_min_u32 s23, s23, 40
    s_mov_b64 exec, -1
    v_mfma_f32_32x32x16_bf16 v[240:255], v[12:15], v[12:15], 0
    s_mov_b64 exec, s[46:47]
    v_bfe_u32 v26, v144, 15, 12
    ds_read_b64 v[52:53], v26 offset:0
    s_mov_b64 exec, s[38:39]
    s_waitcnt lgkmcnt(8)
    v_add_u32 v70, v54, v122
    v_bfe_u32 v70, v70, v121, 8
    v_lshl_add_u32 v74, v70, 6, v55
    v_max_u32 v43, v43, v70
    v_and_b32 v74, 0xffffff, v74
    v_sub_u32_sdwa v75, v74, v55 dst_sel:DWORD dst_unused:UNUSED_PAD src0_sel:DWORD src1_sel:BYTE_3
    ds_write_b64 v74, v[118:119]
    ds_write_b16 v75, v120 offset:48
    s_mov_b64 exec, -1
    v_mul_f32 v91, 0x47800000, v91
    v_cvt_u32_f32 v91, v91
    v_add_u32 v91, 2, v91
    s_bfm_b64 s[78:79], s23, 0
    s_and_b32 s3, s17, 31
    s_lshl_b32 s3, s3, 2
    s_add_u32 s3, s3, s16
    s_mul_i32 s3, s3, 1536
    s_add_u32 s3, s3, s89
    s_add_u32 s3, s3, 589824
    s_mov_b32 exec_lo, 0xfff
    s_mov_b32 exec_hi, 0x0
    buffer_load_dword v31, v111, s[4:7], s3 offen
    s_mov_b64 exec, s[48:49]
    v_bfe_u32 v27, v150, 15, 12
    ds_read_b64 v[54:55], v27 offset:0
    s_mov_b64 exec, s[40:41]
    s_waitcnt lgkmcnt(10)
    v_add_u32 v72, v56, v128
    v_bfe_u32 v72, v72, v127, 8
    v_lshl_add_u32 v76, v72, 6, v57
    v_max_u32 v43, v43, v72
    v_and_b32 v76, 0xffffff, v76
    v_sub_u32_sdwa v77, v76, v57 dst_sel:DWORD dst_unused:UNUSED_PAD src0_sel:DWORD src1_sel:BYTE_3
    ds_write_b64 v76, v[124:125]
    ds_write_b16 v77, v126 offset:48
    s_mov_b64 exec, -1
    v_mul_u32_u24 v92, v82, v91
    v_mul_u32_u24 v93, v83, v91
    v_mul_u32_u24 v94, v84, v91
    v_mul_u32_u24 v95, v85, v91
    v_mul_u32_u24 v96, v86, v91
    s_mov_b64 exec, -1
    v_mfma_f32_32x32x16_bf16 v[112:127], v[12:15], v[12:15], 0
    s_mov_b64 exec, s[50:51]
    v_bfe_u32 v26, v156, 15, 12
    ds_read_b64 v[56:57], v26 offset:0
    s_mov_b64 exec, s[42:43]
    s_waitcnt lgkmcnt(12)
    v_add_u32 v70, v58, v134
    v_bfe_u32 v70, v70, v133, 8
    v_lshl_add_u32 v74, v70, 6, v59
    v_max_u32 v43, v43, v70
    v_and_b32 v74, 0xffffff, v74
    v_sub_u32_sdwa v75, v74, v59 dst_sel:DWORD dst_unused:UNUSED_PAD src0_sel:DWORD src1_sel:BYTE_3
    ds_write_b64 v74, v[130:131]
    ds_write_b16 v75, v132 offset:48
    s_mov_b64 exec, -1
    v_mul_u32_u24 v98, v0, v92
    v_mul_u32_u24 v99, v0, v93
    v_mul_u32_u24 v100, v0, v94
    v_mul_u32_u24 v101, v0, v95
    v_mul_u32_u24 v102, v0, v96
    s_mov_b64 exec, s[52:53]
    v_bfe_u32 v27, v162, 15, 12
    ds_read_b64 v[58:59], v27 offset:0
    s_mov_b64 exec, s[44:45]
    s_waitcnt lgkmcnt(12)
    v_add_u32 v72, v50, v140
    v_bfe_u32 v72, v72, v139, 8
    v_lshl_add_u32 v76, v72, 6, v51
    v_max_u32 v43, v43, v72
    v_and_b32 v76, 0xffffff, v76
    v_sub_u32_sdwa v77, v76, v51 dst_sel:DWORD dst_unused:UNUSED_PAD src0_sel:DWORD src1_sel:BYTE_3
    ds_write_b64 v76, v[136:137]
    ds_write_b16 v77, v138 offset:48
    s_mov_b64 exec, -1
    v_add_u32 v92, v98, v92
    v_add_u32 v93, v99, v93
    v_add_u32 v94, v100, v94
    v_add_u32 v95, v101, v95
    v_add_u32 v96, v102, v96
    s_and_b32 s3, s17, 31
    s_lshl_b32 s3, s3, 2
    s_add_u32 s3, s3, s16
    s_mul_i32 s3, s3, 1536
    s_add_u32 s3, s3, s89
    s_add_u32 s3, s3, 786432
    s_mov_b32 exec_lo, 0xfff
    s_mov_b32 exec_hi, 0x0
    buffer_load_dword v31, v111, s[4:7], s3 offen
    s_mov_b64 exec, s[54:55]
    v_bfe_u32 v26, v168, 15, 12
    ds_read_b64 v[50:51], v26 offset:0
    s_mov_b64 exec, s[46:47]
    s_waitcnt lgkmcnt(12)
    v_add_u32 v70, v52, v146
    v_bfe_u32 v70, v70, v145, 8
    v_lshl_add_u32 v74, v70, 6, v53
    v_max_u32 v43, v43, v70
    v_and_b32 v74, 0xffffff, v74
    v_sub_u32_sdwa v75, v74, v53 dst_sel:DWORD dst_unused:UNUSED_PAD src0_sel:DWORD src1_sel:BYTE_3
    ds_write_b64 v74, v[142:143]
    ds_write_b16 v75, v144 offset:48
    s_mov_b64 exec, -1
    v_lshrrev_b32 v98, 16, v98
    v_lshrrev_b32 v99, 16, v99
    v_lshrrev_b32 v100, 16, v100
    v_lshrrev_b32 v101, 16, v101
    v_lshrrev_b32 v102, 16, v102
    s_mov_b64 exec, -1
    v_mfma_f32_32x32x16_bf16 v[128:143], v[12:15], v[12:15], 0
    s_mov_b64 exec, s[56:57]
    v_bfe_u32 v27, v174, 15, 12
    ds_read_b64 v[52:53], v27 offset:0
    s_mov_b64 exec, s[48:49]
    s_waitcnt lgkmcnt(12)
    v_add_u32 v72, v54, v152
    v_bfe_u32 v72, v72, v151, 8
    v_lshl_add_u32 v76, v72, 6, v55
    v_max_u32 v43, v43, v72
    v_and_b32 v76, 0xffffff, v76
    v_sub_u32_sdwa v77, v76, v55 dst_sel:DWORD dst_unused:UNUSED_PAD src0_sel:DWORD src1_sel:BYTE_3
    ds_write_b64 v76, v[148:149]
    ds_write_b16 v77, v150 offset:48
    s_mov_b64 exec, -1
    v_lshrrev_b32 v92, 16, v92
    v_lshrrev_b32 v93, 16, v93
    v_lshrrev_b32 v94, 16, v94
    v_lshrrev_b32 v95, 16, v95
    v_lshrrev_b32 v96, 16, v96
    s_mov_b64 exec, s[58:59]
    v_bfe_u32 v26, v180, 15, 12
    ds_read_b64 v[54:55], v26 offset:0
    s_mov_b64 exec, s[50:51]
    s_waitcnt lgkmcnt(12)
    v_add_u32 v70, v56, v158
    v_bfe_u32 v70, v70, v157, 8
    v_lshl_add_u32 v74, v70, 6, v57
    v_max_u32 v43, v43, v70
    v_and_b32 v74, 0xffffff, v74
    v_sub_u32_sdwa v75, v74, v57 dst_sel:DWORD dst_unused:UNUSED_PAD src0_sel:DWORD src1_sel:BYTE_3
    ds_write_b64 v74, v[154:155]
    ds_write_b16 v75, v156 offset:48
    s_mov_b64 exec, -1
    v_cmp_gt_u32 s[24:25], v92, v98
    v_cmp_gt_u32 s[26:27], v93, v99
    v_cmp_gt_u32 s[28:29], v94, v100
    v_cmp_gt_u32 s[30:31], v95, v101
    v_cmp_gt_u32 s[32:33], v96, v102
    s_mul_i32 s81, s16, 848
    s_mov_b32 s80, s20
    s_and_b32 s3, s17, 31
    s_lshl_b32 s3, s3, 2
    s_add_u32 s3, s3, s16
    s_mul_i32 s3, s3, 1536
    s_add_u32 s3, s3, s89
    s_add_u32 s3, s3, 983040
    s_mov_b32 exec_lo, 0xfff
    s_mov_b32 exec_hi, 0x0
    buffer_load_dword v31, v111, s[4:7], s3 offen
    s_mov_b64 exec, -1
    v_mfma_f32_32x32x16_bf16 v[144:159], v[12:15], v[12:15], 0
    s_mov_b64 exec, s[60:61]
    v_bfe_u32 v27, v186, 15, 12
    ds_read_b64 v[56:57], v27 offset:0
    s_mov_b64 exec, s[52:53]
    s_waitcnt lgkmcnt(12)
    v_add_u32 v72, v58, v164
    v_bfe_u32 v72, v72, v163, 8
    v_lshl_add_u32 v76, v72, 6, v59
    v_max_u32 v43, v43, v72
    v_and_b32 v76, 0xffffff, v76
    v_sub_u32_sdwa v77, v76, v59 dst_sel:DWORD dst_unused:UNUSED_PAD src0_sel:DWORD src1_sel:BYTE_3
    ds_write_b64 v76, v[160:161]
    ds_write_b16 v77, v162 offset:48
    s_mov_b64 exec, -1
    s_and_b64 s[24:25], s[24:25], s[78:79]
    s_and_b64 s[26:27], s[26:27], s[78:79]
    s_and_b64 s[28:29], s[28:29], s[78:79]
    s_and_b64 s[30:31], s[30:31], s[78:79]
    s_and_b64 s[32:33], s[32:33], s[78:79]
    v_mov_b32 v91, 0
    v_mov_b32 v3, s81
    s_mov_b64 exec, s[62:63]
    v_bfe_u32 v26, v192, 15, 12
    ds_read_b64 v[58:59], v26 offset:0
    s_mov_b64 exec, s[54:55]
    s_waitcnt lgkmcnt(12)
    v_add_u32 v70, v50, v170
    v_bfe_u32 v70, v70, v169, 8
    v_lshl_add_u32 v74, v70, 6, v51
    v_max_u32 v43, v43, v70
    v_and_b32 v74, 0xffffff, v74
    v_sub_u32_sdwa v75, v74, v51 dst_sel:DWORD dst_unused:UNUSED_PAD src0_sel:DWORD src1_sel:BYTE_3
    ds_write_b64 v74, v[166:167]
    ds_write_b16 v75, v168 offset:48
    s_mov_b64 exec, -1
    v_mbcnt_lo_u32_b32 v91, s24, v91
    v_mbcnt_hi_u32_b32 v91, s25, v91
    v_mbcnt_lo_u32_b32 v91, s26, v91
    v_mbcnt_hi_u32_b32 v91, s27, v91
    v_mbcnt_lo_u32_b32 v91, s28, v91
    v_mbcnt_hi_u32_b32 v91, s29, v91
    s_mov_b64 exec, s[64:65]
    v_bfe_u32 v27, v198, 15, 12
    ds_read_b64 v[50:51], v27 offset:0
    s_mov_b64 exec, s[56:57]
    s_waitcnt lgkmcnt(12)
    v_add_u32 v72, v52, v176
    v_bfe_u32 v72, v72, v175, 8
    v_lshl_add_u32 v76, v72, 6, v53
    v_max_u32 v43, v43, v72
    v_and_b32 v76, 0xffffff, v76
    v_sub_u32_sdwa v77, v76, v53 dst_sel:DWORD dst_unused:UNUSED_PAD src0_sel:DWORD src1_sel:BYTE_3
    ds_write_b64 v76, v[172:173]
    ds_write_b16 v77, v174 offset:48
    s_mov_b64 exec, -1
    v_mbcnt_lo_u32_b32 v91, s30, v91
    v_mbcnt_hi_u32_b32 v91, s31, v91
    v_mbcnt_lo_u32_b32 v91, s32, v91
    v_mbcnt_hi_u32_b32 v91, s33, v91
    v_lshl_add_u32 v91, v91, 2, s81
    s_and_b32 s3, s17, 31
    s_lshl_b32 s3, s3, 2
    s_add_u32 s3, s3, s16
    s_mul_i32 s3, s3, 1536
    s_add_u32 s3, s3, s89
    s_add_u32 s3, s3, 1179648
    s_mov_b32 exec_lo, 0xfff
    s_mov_b32 exec_hi, 0x0
    buffer_load_dword v31, v111, s[4:7], s3 offen
    s_mov_b64 exec, -1
    v_mfma_f32_32x32x16_bf16 v[160:175], v[12:15], v[12:15], 0
    s_mov_b64 exec, s[66:67]
    v_bfe_u32 v26, v204, 15, 12
    ds_read_b64 v[52:53], v26 offset:0
    s_mov_b64 exec, s[58:59]
    s_waitcnt lgkmcnt(12)
    v_add_u32 v70, v54, v182
    v_bfe_u32 v70, v70, v181, 8
    v_lshl_add_u32 v74, v70, 6, v55
    v_max_u32 v43, v43, v70
    v_and_b32 v74, 0xffffff, v74
    v_sub_u32_sdwa v75, v74, v55 dst_sel:DWORD dst_unused:UNUSED_PAD src0_sel:DWORD src1_sel:BYTE_3
    ds_write_b64 v74, v[178:179]
    ds_write_b16 v75, v180 offset:48
    s_mov_b64 exec, -1
    v_lshl_add_u32 v98, v98, 7, s80
    s_mov_b64 exec, s[24:25]
    ds_write_b32 v91, v98 offset:6016
    v_add_u32 v91, 4, v91
    s_add_u32 s80, s80, 5136
    s_mov_b64 exec, s[68:69]
    v_bfe_u32 v27, v210, 15, 12
    ds_read_b64 v[54:55], v27 offset:0
    s_mov_b64 exec, s[60:61]
    s_waitcnt lgkmcnt(13)
    v_add_u32 v72, v56, v188
    v_bfe_u32 v72, v72, v187, 8
    v_lshl_add_u32 v76, v72, 6, v57
    v_max_u32 v43, v43, v72
    v_and_b32 v76, 0xffffff, v76
    v_sub_u32_sdwa v77, v76, v57 dst_sel:DWORD dst_unused:UNUSED_PAD src0_sel:DWORD src1_sel:BYTE_3
    ds_write_b64 v76, v[184:185]
    ds_write_b16 v77, v186 offset:48
    s_mov_b64 exec, -1
    v_lshl_add_u32 v99, v99, 7, s80
    s_mov_b64 exec, s[26:27]
    ds_write_b32 v91, v99 offset:6016
    v_add_u32 v91, 4, v91
    s_add_u32 s80, s80, 5136
    s_mov_b64 exec, s[70:71]
    v_bfe_u32 v26, v216, 15, 12
    ds_read_b64 v[56:57], v26 offset:0
    s_mov_b64 exec, s[62:63]
    s_waitcnt lgkmcnt(14)
    v_add_u32 v70, v58, v194
    v_bfe_u32 v70, v70, v193, 8
    v_lshl_add_u32 v74, v70, 6, v59
    v_max_u32 v43, v43, v70
    v_and_b32 v74, 0xffffff, v74
    v_sub_u32_sdwa v75, v74, v59 dst_sel:DWORD dst_unused:UNUSED_PAD src0_sel:DWORD src1_sel:BYTE_3
    ds_write_b64 v74, v[190:191]
    ds_write_b16 v75, v192 offset:48
    s_mov_b64 exec, -1
    v_lshl_add_u32 v100, v100, 7, s80
    s_mov_b64 exec, s[28:29]
    ds_write_b32 v91, v100 offset:6016
    v_add_u32 v91, 4, v91
    s_add_u32 s80, s80, 5136
    s_and_b32 s3, s17, 31
    s_lshl_b32 s3, s3, 2
    s_add_u32 s3, s3, s16
    s_mul_i32 s3, s3, 1664
    s_add_u32 s3, s3, s89
    s_add_u32 s3, s3, 1376256
    s_mov_b32 exec_lo, 0x1fff
    s_mov_b32 exec_hi, 0x0
    buffer_load_dword v31, v111, s[4:7], s3 offen
    s_mov_b64 exec, -1
    v_mfma_f32_32x32x16_bf16 v[176:191], v[12:15], v[12:15], 0
    s_mov_b64 exec, s[72:73]
    v_bfe_u32 v27, v222, 15, 12
    ds_read_b64 v[58:59], v27 offset:0
    s_mov_b64 exec, s[64:65]
    s_waitcnt lgkmcnt(15)
    v_add_u32 v72, v50, v200
    v_bfe_u32 v72, v72, v199, 8
    v_lshl_add_u32 v76, v72, 6, v51
    v_max_u32 v43, v43, v72
    v_and_b32 v76, 0xffffff, v76
    v_sub_u32_sdwa v77, v76, v51 dst_sel:DWORD dst_unused:UNUSED_PAD src0_sel:DWORD src1_sel:BYTE_3
    ds_write_b64 v76, v[196:197]
    ds_write_b16 v77, v198 offset:48
    s_mov_b64 exec, -1
    v_lshl_add_u32 v101, v101, 7, s80
    s_mov_b64 exec, s[30:31]
    ds_write_b32 v91, v101 offset:6016
    v_add_u32 v91, 4, v91
    s_add_u32 s80, s80, 5136
    s_mov_b64 exec, s[74:75]
    v_bfe_u32 v26, v228, 15, 12
    ds_read_b64 v[50:51], v26 offset:0
    s_mov_b64 exec, s[66:67]
    s_waitcnt lgkmcnt(15)
    v_add_u32 v70, v52, v206
    v_bfe_u32 v70, v70, v205, 8
    v_lshl_add_u32 v74, v70, 6, v53
    v_max_u32 v43, v43, v70
    v_and_b32 v74, 0xffffff, v74
    v_sub_u32_sdwa v75, v74, v53 dst_sel:DWORD dst_unused:UNUSED_PAD src0_sel:DWORD src1_sel:BYTE_3
    ds_write_b64 v74, v[202:203]
    ds_write_b16 v75, v204 offset:48
    s_mov_b64 exec, -1
    v_lshl_add_u32 v102, v102, 7, s80
    s_mov_b64 exec, s[32:33]
    ds_write_b32 v91, v102 offset:6016
    v_add_u32 v91, 4, v91
    s_mov_b64 exec, -1
    v_mfma_f32_32x32x16_bf16 v[192:207], v[12:15], v[12:15], 0
    s_mov_b64 exec, s[76:77]
    v_bfe_u32 v27, v234, 15, 12
    ds_read_b64 v[52:53], v27 offset:0
    s_mov_b64 exec, s[68:69]
    s_waitcnt lgkmcnt(15)
    v_add_u32 v72, v54, v212
    v_bfe_u32 v72, v72, v211, 8
    v_lshl_add_u32 v76, v72, 6, v55
    v_max_u32 v43, v43, v72
    v_and_b32 v76, 0xffffff, v76
    v_sub_u32_sdwa v77, v76, v55 dst_sel:DWORD dst_unused:UNUSED_PAD src0_sel:DWORD src1_sel:BYTE_3
    ds_write_b64 v76, v[208:209]
    ds_write_b16 v77, v210 offset:48
    s_mov_b64 exec, s[70:71]
    s_waitcnt lgkmcnt(14)
    v_add_u32 v70, v56, v218
    v_bfe_u32 v70, v70, v217, 8
    v_lshl_add_u32 v74, v70, 6, v57
    v_max_u32 v43, v43, v70
    v_and_b32 v74, 0xffffff, v74
    v_sub_u32_sdwa v75, v74, v57 dst_sel:DWORD dst_unused:UNUSED_PAD src0_sel:DWORD src1_sel:BYTE_3
    ds_write_b64 v74, v[214:215]
    ds_write_b16 v75, v216 offset:48
    s_mov_b64 exec, s[72:73]
    s_waitcnt lgkmcnt(12)
    v_add_u32 v72, v58, v224
    v_bfe_u32 v72, v72, v223, 8
    v_lshl_add_u32 v76, v72, 6, v59
    v_max_u32 v43, v43, v72
    v_and_b32 v76, 0xffffff, v76
    v_sub_u32_sdwa v77, v76, v59 dst_sel:DWORD dst_unused:UNUSED_PAD src0_sel:DWORD src1_sel:BYTE_3
    ds_write_b64 v76, v[220:221]
    ds_write_b16 v77, v222 offset:48
    s_mov_b64 exec, -1
    v_mfma_f32_32x32x16_bf16 v[208:223], v[12:15], v[12:15], 0
    s_mov_b64 exec, s[74:75]
    s_waitcnt lgkmcnt(10)
    v_add_u32 v70, v50, v230
    v_bfe_u32 v70, v70, v229, 8
    v_lshl_add_u32 v74, v70, 6, v51
    v_max_u32 v43, v43, v70
    v_and_b32 v74, 0xffffff, v74
    v_sub_u32_sdwa v75, v74, v51 dst_sel:DWORD dst_unused:UNUSED_PAD src0_sel:DWORD src1_sel:BYTE_3
    ds_write_b64 v74, v[226:227]
    ds_write_b16 v75, v228 offset:48
    s_mov_b64 exec, s[76:77]
    s_waitcnt lgkmcnt(8)
    v_add_u32 v72, v52, v236
    v_bfe_u32 v72, v72, v235, 8
    v_lshl_add_u32 v76, v72, 6, v53
    v_max_u32 v43, v43, v72
    v_and_b32 v76, 0xffffff, v76
    v_sub_u32_sdwa v77, v76, v53 dst_sel:DWORD dst_unused:UNUSED_PAD src0_sel:DWORD src1_sel:BYTE_3
    ds_write_b64 v76, v[232:233]
    ds_write_b16 v77, v234 offset:48
    s_mov_b64 exec, -1
    v_mfma_f32_32x32x16_bf16 v[224:239], v[12:15], v[12:15], 0
L_s_done:
    s_mov_b64 exec, -1
    v_cmp_le_u32 vcc, 80, v43
    v_mov_b32 v70, 1
    v_mov_b32 v71, 0
    s_cbranch_vccz L_deg_ok
    ds_write_b32 v71, v70 offset:4480
L_deg_ok:
    ds_read_b128 v[48:51], v3 offset:6016
    ds_read_b32 v4, v3 offset:6032
    s_mov_b32 s22, 0
    s_waitcnt vmcnt(6) lgkmcnt(0)
    v_add_u32 v47, v48, v2
    v_add_u32 v29, v49, v2
    v_add_u32 v30, v50, v2
    v_add_u32 v28, v51, v2
    v_mov_b32 v49, 0
    s_barrier
    ds_read_b32 v48, v49 offset:4480
    ds_read_b96 v[36:38], v47 offset:48
    ds_read_b96 v[40:42], v29 offset:48
    ds_read_b96 v[44:46], v30 offset:48
    ds_read_b96 v[32:34], v28 offset:48
    ds_read_b128 v[16:19], v47
    ds_read_b128 v[20:23], v47 offset:16
    ds_read_b64 v[24:25], v47 offset:32
    s_waitcnt lgkmcnt(7)
    v_readfirstlane_b32 s78, v48
    s_andn2_b32 s78, s78, s82
    s_cmp_lg_u32 s78, 0
    s_cbranch_scc1 L_to_slow
    s_cmp_eq_u32 s23, 0
    s_cbranch_scc1 L_nomain
    s_waitcnt lgkmcnt(6)
    v_mad_u32_u16 v26, v36, s21, v1
    buffer_load_dwordx4 v[52:55], v26, s[4:7], 0 offen
    v_mad_u32_u16 v27, v36, s21, v1 op_sel:[1,0,0,0]
    buffer_load_dwordx4 v[56:59], v27, s[4:7], 0 offen
    v_mad_u32_u16 v26, v37, s21, v1
    buffer_load_dwordx4 v[60:63], v26, s[4:7], 0 offen
    v_mad_u32_u16 v27, v37, s21, v1 op_sel:[1,0,0,0]
    buffer_load_dwordx4 v[64:67], v27, s[4:7], 0 offen
    v_mad_u32_u16 v26, v38, s21, v1
    buffer_load_dwordx4 v[68:71], v26, s[4:7], 0 offen
    s_waitcnt lgkmcnt(5)
    v_mad_u32_u16 v26, v40, s21, v1
    buffer_load_dwordx4 v[72:75], v26, s[4:7], 0 offen
    v_mad_u32_u16 v27, v40, s21, v1 op_sel:[1,0,0,0]
    buffer_load_dwordx4 v[76:79], v27, s[4:7], 0 offen
    v_mad_u32_u16 v26, v41, s21, v1
    buffer_load_dwordx4 v[80:83], v26, s[4:7], 0 offen
    v_mad_u32_u16 v27, v41, s21, v1 op_sel:[1,0,0,0]
    buffer_load_dwordx4 v[84:87], v27, s[4:7], 0 offen
    v_mad_u32_u16 v26, v42, s21, v1
    buffer_load_dwordx4 v[88:91], v26, s[4:7], 0 offen
    s_waitcnt lgkmcnt(4)
    v_mad_u32_u16 v26, v44, s21, v1
    buffer_load_dwordx4 v[92:95], v26, s[4:7], 0 offen
    v_mad_u32_u16 v27, v44, s21, v1 op_sel:[1,0,0,0]
    buffer_load_dwordx4 v[96:99], v27, s[4:7], 0 offen
    v_mad_u32_u16 v26, v45, s21, v1
    buffer_load_dwordx4 v[100:103], v26, s[4:7], 0 offen
    v_mad_u32_u16 v27, v45, s21, v1 op_sel:[1,0,0,0]
    buffer_load_dwordx4 v[104:107], v27, s[4:7], 0 offen
    v_mad_u32_u16 v26, v46, s21, v1
    buffer_load_dwordx4 v[108:111], v26, s[4:7], 0 offen
    s_waitcnt lgkmcnt(0)
    v_and_b32 v49, 31, v0
    v_lshrrev_b32 v50, 5, v0
    v_lshlrev_b32 v44, 3, v49
    v_lshl_add_u32 v44, v50, 8, v44
    v_add_u32 v44, s20, v44
    v_min_u32 v45, 24, v49
    v_mul_u32_u24 v45, 1040, v45
    v_lshl_add_u32 v45, v50, 4, v45
    v_add_u32 v45, s20, v45
    v_lshlrev_b32 v46, 4, v0
    v_lshlrev_b32 v47, 2, v49
    s_lshl_b32 s78, s16, 7
    v_lshl_add_u32 v48, v50, 4, s78
L_blk0:
    s_waitcnt lgkmcnt(3)
    v_add_u32 v5, v4, v2
    ds_read_b96 v[36:38], v5 offset:48
    ds_read_b32 v4, v3 offset:6036
    s_waitcnt vmcnt(14) lgkmcnt(4)
    v_perm_b32 v12, v17, v16, v8
    v_perm_b32 v13, v17, v16, v9
    v_perm_b32 v14, v17, v16, v10
    v_perm_b32 v15, v17, v16, v11
    v_mad_u32_u16 v26, v32, s21, v1
    s_bitcmp1_b64 s[26:27], s22
    v_mfma_f32_32x32x16_bf16 a[0:15], v[12:15], v[52:55], a[0:15]
    buffer_load_dwordx4 v[52:55], v26, s[4:7], 0 offen
    s_waitcnt vmcnt(14)
    v_perm_b32 v12, v19, v18, v8
    v_perm_b32 v13, v19, v18, v9
    v_perm_b32 v14, v19, v18, v10
    v_perm_b32 v15, v19, v18, v11
    v_mad_u32_u16 v27, v32, s21, v1 op_sel:[1,0,0,0]
    ds_read_b128 v[16:19], v29
    v_mfma_f32_32x32x16_bf16 a[16:31], v[12:15], v[56:59], a[16:31]
    buffer_load_dwordx4 v[56:59], v27, s[4:7], 0 offen
    s_waitcnt vmcnt(14) lgkmcnt(4)
    v_perm_b32 v12, v21, v20, v8
    v_perm_b32 v13, v21, v20, v9
    v_perm_b32 v14, v21, v20, v10
    v_perm_b32 v15, v21, v20, v11
    v_mad_u32_u16 v26, v33, s21, v1
    s_nop 0
    v_mfma_f32_32x32x16_bf16 a[32:47], v[12:15], v[60:63], a[32:47]
    buffer_load_dwordx4 v[60:63], v26, s[4:7], 0 offen
    s_waitcnt vmcnt(14)
    v_perm_b32 v12, v23, v22, v8
    v_perm_b32 v13, v23, v22, v9
    v_perm_b32 v14, v23, v22, v10
    v_perm_b32 v15, v23, v22, v11
    v_mad_u32_u16 v27, v33, s21, v1 op_sel:[1,0,0,0]
    ds_read_b128 v[20:23], v29 offset:16
    v_mfma_f32_32x32x16_bf16 a[48:63], v[12:15], v[64:67], a[48:63]
    buffer_load_dwordx4 v[64:67], v27, s[4:7], 0 offen
    s_waitcnt vmcnt(14) lgkmcnt(4)
    v_perm_b32 v12, v25, v24, v8
    v_perm_b32 v13, v25, v24, v9
    v_perm_b32 v14, v25, v24, v10
    v_perm_b32 v15, v25, v24, v11
    v_mad_u32_u16 v26, v34, s21, v1
    ds_read_b64 v[24:25], v29 offset:32
    v_mfma_f32_32x32x16_bf16 a[64:79], v[12:15], v[68:71], a[64:79]
    buffer_load_dwordx4 v[68:71], v26, s[4:7], 0 offen
    v_mov_b32 v29, v5
    s_cbranch_scc0 L_stub0
L_blk1:
    s_waitcnt lgkmcnt(3)
    v_add_u32 v5, v4, v2
    ds_read_b96 v[40:42], v5 offset:48
    ds_read_b32 v4, v3 offset:6040
    s_waitcnt vmcnt(14) lgkmcnt(4)
    v_perm_b32 v12, v17, v16, v8
    v_perm_b32 v13, v17, v16, v9
    v_perm_b32 v14, v17, v16, v10
    v_perm_b32 v15, v17, v16, v11
    v_mad_u32_u16 v26, v36, s21, v1
    s_bitcmp1_b64 s[28:29], s22
    v_mfma_f32_32x32x16_bf16 a[80:95], v[12:15], v[72:75], a[80:95]
    buffer_load_dwordx4 v[72:75], v26, s[4:7], 0 offen
    s_waitcnt vmcnt(14)
    v_perm_b32 v12, v19, v18, v8
    v_perm_b32 v13, v19, v18, v9
    v_perm_b32 v14, v19, v18, v10
    v_perm_b32 v15, v19, v18, v11
    v_mad_u32_u16 v27, v36, s21, v1 op_sel:[1,0,0,0]
    ds_read_b128 v[16:19], v30
    v_mfma_f32_32x32x16_bf16 a[96:111], v[12:15], v[76:79], a[96:111]
    buffer_load_dwordx4 v[76:79], v27, s[4:7], 0 offen
    s_waitcnt vmcnt(14) lgkmcnt(4)
    v_perm_b32 v12, v21, v20, v8
    v_perm_b32 v13, v21, v20, v9
    v_perm_b32 v14, v21, v20, v10
    v_perm_b32 v15, v21, v20, v11
    v_mad_u32_u16 v26, v37, s21, v1
    s_nop 0
    v_mfma_f32_32x32x16_bf16 a[112:127], v[12:15], v[80:83], a[112:127]
    buffer_load_dwordx4 v[80:83], v26, s[4:7], 0 offen
    s_waitcnt vmcnt(14)
    v_perm_b32 v12, v23, v22, v8
    v_perm_b32 v13, v23, v22, v9
    v_perm_b32 v14, v23, v22, v10
    v_perm_b32 v15, v23, v22, v11
    v_mad_u32_u16 v27, v37, s21, v1 op_sel:[1,0,0,0]
    ds_read_b128 v[20:23], v30 offset:16
    v_mfma_f32_32x32x16_bf16 a[128:143], v[12:15], v[84:87], a[128:143]
    buffer_load_dwordx4 v[84:87], v27, s[4:7], 0 offen
    s_waitcnt vmcnt(14) lgkmcnt(4)
    v_perm_b32 v12, v25, v24, v8
    v_perm_b32 v13, v25, v24, v9
    v_perm_b32 v14, v25, v24, v10
    v_perm_b32 v15, v25, v24, v11
    v_mad_u32_u16 v26, v38, s21, v1
    ds_read_b64 v[24:25], v30 offset:32
    v_mfma_f32_32x32x16_bf16 a[144:159], v[12:15], v[88:91], a[144:159]
    buffer_load_dwordx4 v[88:91], v26, s[4:7], 0 offen
    v_mov_b32 v30, v5
    s_cbranch_scc0 L_stub1
L_blk2:
    s_waitcnt lgkmcnt(3)
    v_add_u32 v5, v4, v2
    ds_read_b96 v[32:34], v5 offset:48
    ds_read_b32 v4, v3 offset:6044
    s_waitcnt vmcnt(14) lgkmcnt(4)
    v_perm_b32 v12, v17, v16, v8
    v_perm_b32 v13, v17, v16, v9
    v_perm_b32 v14, v17, v16, v10
    v_perm_b32 v15, v17, v16, v11
    v_mad_u32_u16 v26, v40, s21, v1
    s_bitcmp1_b64 s[30:31], s22
    v_mfma_f32_32x32x16_bf16 a[160:175], v[12:15], v[92:95], a[160:175]
    buffer_load_dwordx4 v[92:95], v26, s[4:7], 0 offen
    s_waitcnt vmcnt(14)
    v_perm_b32 v12, v19, v18, v8
    v_perm_b32 v13, v19, v18, v9
    v_perm_b32 v14, v19, v18, v10
    v_perm_b32 v15, v19, v18, v11
    v_mad_u32_u16 v27, v40, s21, v1 op_sel:[1,0,0,0]
    ds_read_b128 v[16:19], v28
    v_mfma_f32_32x32x16_bf16 a[176:191], v[12:15], v[96:99], a[176:191]
    buffer_load_dwordx4 v[96:99], v27, s[4:7], 0 offen
    s_waitcnt vmcnt(14) lgkmcnt(4)
    v_perm_b32 v12, v21, v20, v8
    v_perm_b32 v13, v21, v20, v9
    v_perm_b32 v14, v21, v20, v10
    v_perm_b32 v15, v21, v20, v11
    v_mad_u32_u16 v26, v41, s21, v1
    v_add_u32 v3, 12, v3
    v_mfma_f32_32x32x16_bf16 a[192:207], v[12:15], v[100:103], a[192:207]
    buffer_load_dwordx4 v[100:103], v26, s[4:7], 0 offen
    s_waitcnt vmcnt(14)
    v_perm_b32 v12, v23, v22, v8
    v_perm_b32 v13, v23, v22, v9
    v_perm_b32 v14, v23, v22, v10
    v_perm_b32 v15, v23, v22, v11
    v_mad_u32_u16 v27, v41, s21, v1 op_sel:[1,0,0,0]
    ds_read_b128 v[20:23], v28 offset:16
    v_mfma_f32_32x32x16_bf16 a[208:223], v[12:15], v[104:107], a[208:223]
    buffer_load_dwordx4 v[104:107], v27, s[4:7], 0 offen
    s_waitcnt vmcnt(14) lgkmcnt(4)
    v_perm_b32 v12, v25, v24, v8
    v_perm_b32 v13, v25, v24, v9
    v_perm_b32 v14, v25, v24, v10
    v_perm_b32 v15, v25, v24, v11
    v_mad_u32_u16 v26, v42, s21, v1
    ds_read_b64 v[24:25], v28 offset:32
    v_mfma_f32_32x32x16_bf16 a[224:239], v[12:15], v[108:111], a[224:239]
    buffer_load_dwordx4 v[108:111], v26, s[4:7], 0 offen
    v_mov_b32 v28, v5
    s_cbranch_scc0 L_stub2
L_blk3:
    s_waitcnt lgkmcnt(3)
    v_add_u32 v5, v4, v2
    ds_read_b96 v[36:38], v5 offset:48
    ds_read_b32 v4, v3 offset:6036
    s_waitcnt vmcnt(14) lgkmcnt(4)
    v_perm_b32 v12, v17, v16, v8
    v_perm_b32 v13, v17, v16, v9
    v_perm_b32 v14, v17, v16, v10
    v_perm_b32 v15, v17, v16, v11
    v_mad_u32_u16 v26, v32, s21, v1
    s_bitcmp1_b64 s[32:33], s22
    v_mfma_f32_32x32x16_bf16 a[240:255], v[12:15], v[52:55], a[240:255]
    buffer_load_dwordx4 v[52:55], v26, s[4:7], 0 offen
    s_waitcnt vmcnt(14)
    v_perm_b32 v12, v19, v18, v8
    v_perm_b32 v13, v19, v18, v9
    v_perm_b32 v14, v19, v18, v10
    v_perm_b32 v15, v19, v18, v11
    v_mad_u32_u16 v27, v32, s21, v1 op_sel:[1,0,0,0]
    ds_read_b128 v[16:19], v29
    v_mfma_f32_32x32x16_bf16 v[112:127], v[12:15], v[56:59], v[112:127]
    buffer_load_dwordx4 v[56:59], v27, s[4:7], 0 offen
    s_waitcnt vmcnt(14) lgkmcnt(4)
    v_perm_b32 v12, v21, v20, v8
    v_perm_b32 v13, v21, v20, v9
    v_perm_b32 v14, v21, v20, v10
    v_perm_b32 v15, v21, v20, v11
    v_mad_u32_u16 v26, v33, s21, v1
    s_nop 0
    v_mfma_f32_32x32x16_bf16 v[128:143], v[12:15], v[60:63], v[128:143]
    buffer_load_dwordx4 v[60:63], v26, s[4:7], 0 offen
    s_waitcnt vmcnt(14)
    v_perm_b32 v12, v23, v22, v8
    v_perm_b32 v13, v23, v22, v9
    v_perm_b32 v14, v23, v22, v10
    v_perm_b32 v15, v23, v22, v11
    v_mad_u32_u16 v27, v33, s21, v1 op_sel:[1,0,0,0]
    ds_read_b128 v[20:23], v29 offset:16
    v_mfma_f32_32x32x16_bf16 v[144:159], v[12:15], v[64:67], v[144:159]
    buffer_load_dwordx4 v[64:67], v27, s[4:7], 0 offen
    s_waitcnt vmcnt(14) lgkmcnt(4)
    v_perm_b32 v12, v25, v24, v8
    v_perm_b32 v13, v25, v24, v9
    v_perm_b32 v14, v25, v24, v10
    v_perm_b32 v15, v25, v24, v11
    v_mad_u32_u16 v26, v34, s21, v1
    ds_read_b64 v[24:25], v29 offset:32
    v_mfma_f32_32x32x16_bf16 v[160:175], v[12:15], v[68:71], v[160:175]
    buffer_load_dwordx4 v[68:71], v26, s[4:7], 0 offen
    v_mov_b32 v29, v5
    s_cbranch_scc0 L_stub3
L_blk4:
    s_waitcnt lgkmcnt(3)
    v_add_u32 v5, v4, v2
    ds_read_b96 v[40:42], v5 offset:48
    ds_read_b32 v4, v3 offset:6040
    s_waitcnt vmcnt(14) lgkmcnt(4)
    v_perm_b32 v12, v17, v16, v8
    v_perm_b32 v13, v17, v16, v9
    v_perm_b32 v14, v17, v16, v10
    v_perm_b32 v15, v17, v16, v11
    v_mad_u32_u16 v26, v36, s21, v1
    s_add_u32 s22, s22, 1
    v_mfma_f32_32x32x16_bf16 v[176:191], v[12:15], v[72:75], v[176:191]
    buffer_load_dwordx4 v[72:75], v26, s[4:7], 0 offen
    s_waitcnt vmcnt(14)
    v_perm_b32 v12, v19, v18, v8
    v_perm_b32 v13, v19, v18, v9
    v_perm_b32 v14, v19, v18, v10
    v_perm_b32 v15, v19, v18, v11
    v_mad_u32_u16 v27, v36, s21, v1 op_sel:[1,0,0,0]
    ds_read_b128 v[16:19], v30
    v_mfma_f32_32x32x16_bf16 v[192:207], v[12:15], v[76:79], v[192:207]
    buffer_load_dwordx4 v[76:79], v27, s[4:7], 0 offen
    s_waitcnt vmcnt(14) lgkmcnt(4)
    v_perm_b32 v12, v21, v20, v8
    v_perm_b32 v13, v21, v20, v9
    v_perm_b32 v14, v21, v20, v10
    v_perm_b32 v15, v21, v20, v11
    v_mad_u32_u16 v26, v37, s21, v1
    s_cmp_lt_u32 s22, s23
    v_mfma_f32_32x32x16_bf16 v[208:223], v[12:15], v[80:83], v[208:223]
    buffer_load_dwordx4 v[80:83], v26, s[4:7], 0 offen
    s_waitcnt vmcnt(14)
    v_perm_b32 v12, v23, v22, v8
    v_perm_b32 v13, v23, v22, v9
    v_perm_b32 v14, v23, v22, v10
    v_perm_b32 v15, v23, v22, v11
    v_mad_u32_u16 v27, v37, s21, v1 op_sel:[1,0,0,0]
    ds_read_b128 v[20:23], v30 offset:16
    v_mfma_f32_32x32x16_bf16 v[224:239], v[12:15], v[84:87], v[224:239]
    buffer_load_dwordx4 v[84:87], v27, s[4:7], 0 offen
    s_waitcnt vmcnt(14) lgkmcnt(4)
    v_perm_b32 v12, v25, v24, v8
    v_perm_b32 v13, v25, v24, v9
    v_perm_b32 v14, v25, v24, v10
    v_perm_b32 v15, v25, v24, v11
    v_mad_u32_u16 v26, v38, s21, v1
    ds_read_b64 v[24:25], v30 offset:32
    v_mfma_f32_32x32x16_bf16 v[240:255], v[12:15], v[88:91], v[240:255]
    buffer_load_dwordx4 v[88:91], v26, s[4:7], 0 offen
    v_mov_b32 v30, v5
    s_cbranch_scc0 L_exit
L_blk5:
    s_waitcnt lgkmcnt(3)
    v_add_u32 v5, v4, v2
    ds_read_b96 v[32:34], v5 offset:48
    ds_read_b32 v4, v3 offset:6044
    s_waitcnt vmcnt(14) lgkmcnt(4)
    v_perm_b32 v12, v17, v16, v8
    v_perm_b32 v13, v17, v16, v9
    v_perm_b32 v14, v17, v16, v10
    v_perm_b32 v15, v17, v16, v11
    v_mad_u32_u16 v26, v40, s21, v1
    s_bitcmp1_b64 s[26:27], s22
    v_mfma_f32_32x32x16_bf16 a[0:15], v[12:15], v[92:95], a[0:15]
    buffer_load_dwordx4 v[92:95], v26, s[4:7], 0 offen
    s_waitcnt vmcnt(14)
    v_perm_b32 v12, v19, v18, v8
    v_perm_b32 v13, v19, v18, v9
    v_perm_b32 v14, v19, v18, v10
    v_perm_b32 v15, v19, v18, v11
    v_mad_u32_u16 v27, v40, s21, v1 op_sel:[1,0,0,0]
    ds_read_b128 v[16:19], v28
    v_mfma_f32_32x32x16_bf16 a[16:31], v[12:15], v[96:99], a[16:31]
    buffer_load_dwordx4 v[96:99], v27, s[4:7], 0 offen
    s_waitcnt vmcnt(14) lgkmcnt(4)
    v_perm_b32 v12, v21, v20, v8
    v_perm_b32 v13, v21, v20, v9
    v_perm_b32 v14, v21, v20, v10
    v_perm_b32 v15, v21, v20, v11
    v_mad_u32_u16 v26, v41, s21, v1
    v_add_u32 v3, 12, v3
    v_mfma_f32_32x32x16_bf16 a[32:47], v[12:15], v[100:103], a[32:47]
    buffer_load_dwordx4 v[100:103], v26, s[4:7], 0 offen
    s_waitcnt vmcnt(14)
    v_perm_b32 v12, v23, v22, v8
    v_perm_b32 v13, v23, v22, v9
    v_perm_b32 v14, v23, v22, v10
    v_perm_b32 v15, v23, v22, v11
    v_mad_u32_u16 v27, v41, s21, v1 op_sel:[1,0,0,0]
    ds_read_b128 v[20:23], v28 offset:16
    v_mfma_f32_32x32x16_bf16 a[48:63], v[12:15], v[104:107], a[48:63]
    buffer_load_dwordx4 v[104:107], v27, s[4:7], 0 offen
    s_waitcnt vmcnt(14) lgkmcnt(4)
    v_perm_b32 v12, v25, v24, v8
    v_perm_b32 v13, v25, v24, v9
    v_perm_b32 v14, v25, v24, v10
    v_perm_b32 v15, v25, v24, v11
    v_mad_u32_u16 v26, v42, s21, v1
    ds_read_b64 v[24:25], v28 offset:32
    v_mfma_f32_32x32x16_bf16 a[64:79], v[12:15], v[108:111], a[64:79]
    buffer_load_dwordx4 v[108:111], v26, s[4:7], 0 offen
    v_mov_b32 v28, v5
    s_cbranch_scc0 L_stub5
L_blk6:
    s_waitcnt lgkmcnt(3)
    v_add_u32 v5, v4, v2
    ds_read_b96 v[36:38], v5 offset:48
    ds_read_b32 v4, v3 offset:6036
    s_waitcnt vmcnt(14) lgkmcnt(4)
    v_perm_b32 v12, v17, v16, v8
    v_perm_b32 v13, v17, v16, v9
    v_perm_b32 v14, v17, v16, v10
    v_perm_b32 v15, v17, v16, v11
    v_mad_u32_u16 v26, v32, s21, v1
    s_bitcmp1_b64 s[28:29], s22
    v_mfma_f32_32x32x16_bf16 a[80:95], v[12:15], v[52:55], a[80:95]
    buffer_load_dwordx4 v[52:55], v26, s[4:7], 0 offen
    s_waitcnt vmcnt(14)
    v_perm_b32 v12, v19, v18, v8
    v_perm_b32 v13, v19, v18, v9
    v_perm_b32 v14, v19, v18, v10
    v_perm_b32 v15, v19, v18, v11
    v_mad_u32_u16 v27, v32, s21, v1 op_sel:[1,0,0,0]
    ds_read_b128 v[16:19], v29
    v_mfma_f32_32x32x16_bf16 a[96:111], v[12:15], v[56:59], a[96:111]
    buffer_load_dwordx4 v[56:59], v27, s[4:7], 0 offen
    s_waitcnt vmcnt(14) lgkmcnt(4)
    v_perm_b32 v12, v21, v20, v8
    v_perm_b32 v13, v21, v20, v9
    v_perm_b32 v14, v21, v20, v10
    v_perm_b32 v15, v21, v20, v11
    v_mad_u32_u16 v26, v33, s21, v1
    s_nop 0
    v_mfma_f32_32x32x16_bf16 a[112:127], v[12:15], v[60:63], a[112:127]
    buffer_load_dwordx4 v[60:63], v26, s[4:7], 0 offen
    s_waitcnt vmcnt(14)
    v_perm_b32 v12, v23, v22, v8
    v_perm_b32 v13, v23, v22, v9
    v_perm_b32 v14, v23, v22, v10
    v_perm_b32 v15, v23, v22, v11
    v_mad_u32_u16 v27, v33, s21, v1 op_sel:[1,0,0,0]
    ds_read_b128 v[20:23], v29 offset:16
    v_mfma_f32_32x32x16_bf16 a[128:143], v[12:15], v[64:67], a[128:143]
    buffer_load_dwordx4 v[64:67], v27, s[4:7], 0 offen
    s_waitcnt vmcnt(14) lgkmcnt(4)
    v_perm_b32 v12, v25, v24, v8
    v_perm_b32 v13, v25, v24, v9
    v_perm_b32 v14, v25, v24, v10
    v_perm_b32 v15, v25, v24, v11
    v_mad_u32_u16 v26, v34, s21, v1
    ds_read_b64 v[24:25], v29 offset:32
    v_mfma_f32_32x32x16_bf16 a[144:159], v[12:15], v[68:71], a[144:159]
    buffer_load_dwordx4 v[68:71], v26, s[4:7], 0 offen
    v_mov_b32 v29, v5
    s_cbranch_scc0 L_stub6
L_blk7:
    s_waitcnt lgkmcnt(3)
    v_add_u32 v5, v4, v2
    ds_read_b96 v[40:42], v5 offset:48
    ds_read_b32 v4, v3 offset:6040
    s_waitcnt vmcnt(14) lgkmcnt(4)
    v_perm_b32 v12, v17, v16, v8
    v_perm_b32 v13, v17, v16, v9
    v_perm_b32 v14, v17, v16, v10
    v_perm_b32 v15, v17, v16, v11
    v_mad_u32_u16 v26, v36, s21, v1
    s_bitcmp1_b64 s[30:31], s22
    v_mfma_f32_32x32x16_bf16 a[160:175], v[12:15], v[72:75], a[160:175]
    buffer_load_dwordx4 v[72:75], v26, s[4:7], 0 offen
    s_waitcnt vmcnt(14)
    v_perm_b32 v12, v19, v18, v8
    v_perm_b32 v13, v19, v18, v9
    v_perm_b32 v14, v19, v18, v10
    v_perm_b32 v15, v19, v18, v11
    v_mad_u32_u16 v27, v36, s21, v1 op_sel:[1,0,0,0]
    ds_read_b128 v[16:19], v30
    v_mfma_f32_32x32x16_bf16 a[176:191], v[12:15], v[76:79], a[176:191]
    buffer_load_dwordx4 v[76:79], v27, s[4:7], 0 offen
    s_waitcnt vmcnt(14) lgkmcnt(4)
    v_perm_b32 v12, v21, v20, v8
    v_perm_b32 v13, v21, v20, v9
    v_perm_b32 v14, v21, v20, v10
    v_perm_b32 v15, v21, v20, v11
    v_mad_u32_u16 v26, v37, s21, v1
    s_nop 0
    v_mfma_f32_32x32x16_bf16 a[192:207], v[12:15], v[80:83], a[192:207]
    buffer_load_dwordx4 v[80:83], v26, s[4:7], 0 offen
    s_waitcnt vmcnt(14)
    v_perm_b32 v12, v23, v22, v8
    v_perm_b32 v13, v23, v22, v9
    v_perm_b32 v14, v23, v22, v10
    v_perm_b32 v15, v23, v22, v11
    v_mad_u32_u16 v27, v37, s21, v1 op_sel:[1,0,0,0]
    ds_read_b128 v[20:23], v30 offset:16
    v_mfma_f32_32x32x16_bf16 a[208:223], v[12:15], v[84:87], a[208:223]
    buffer_load_dwordx4 v[84:87], v27, s[4:7], 0 offen
    s_waitcnt vmcnt(14) lgkmcnt(4)
    v_perm_b32 v12, v25, v24, v8
    v_perm_b32 v13, v25, v24, v9
    v_perm_b32 v14, v25, v24, v10
    v_perm_b32 v15, v25, v24, v11
    v_mad_u32_u16 v26, v38, s21, v1
    ds_read_b64 v[24:25], v30 offset:32
    v_mfma_f32_32x32x16_bf16 a[224:239], v[12:15], v[88:91], a[224:239]
    buffer_load_dwordx4 v[88:91], v26, s[4:7], 0 offen
    v_mov_b32 v30, v5
    s_cbranch_scc0 L_stub7
L_blk8:
    s_waitcnt lgkmcnt(3)
    v_add_u32 v5, v4, v2
    ds_read_b96 v[32:34], v5 offset:48
    ds_read_b32 v4, v3 offset:6044
    s_waitcnt vmcnt(14) lgkmcnt(4)
    v_perm_b32 v12, v17, v16, v8
    v_perm_b32 v13, v17, v16, v9
    v_perm_b32 v14, v17, v16, v10
    v_perm_b32 v15, v17, v16, v11
    v_mad_u32_u16 v26, v40, s21, v1
    s_bitcmp1_b64 s[32:33], s22
    v_mfma_f32_32x32x16_bf16 a[240:255], v[12:15], v[92:95], a[240:255]
    buffer_load_dwordx4 v[92:95], v26, s[4:7], 0 offen
    s_waitcnt vmcnt(14)
    v_perm_b32 v12, v19, v18, v8
    v_perm_b32 v13, v19, v18, v9
    v_perm_b32 v14, v19, v18, v10
    v_perm_b32 v15, v19, v18, v11
    v_mad_u32_u16 v27, v40, s21, v1 op_sel:[1,0,0,0]
    ds_read_b128 v[16:19], v28
    v_mfma_f32_32x32x16_bf16 v[112:127], v[12:15], v[96:99], v[112:127]
    buffer_load_dwordx4 v[96:99], v27, s[4:7], 0 offen
    s_waitcnt vmcnt(14) lgkmcnt(4)
    v_perm_b32 v12, v21, v20, v8
    v_perm_b32 v13, v21, v20, v9
    v_perm_b32 v14, v21, v20, v10
    v_perm_b32 v15, v21, v20, v11
    v_mad_u32_u16 v26, v41, s21, v1
    v_add_u32 v3, 12, v3
    v_mfma_f32_32x32x16_bf16 v[128:143], v[12:15], v[100:103], v[128:143]
    buffer_load_dwordx4 v[100:103], v26, s[4:7], 0 offen
    s_waitcnt vmcnt(14)
    v_perm_b32 v12, v23, v22, v8
    v_perm_b32 v13, v23, v22, v9
    v_perm_b32 v14, v23, v22, v10
    v_perm_b32 v15, v23, v22, v11
    v_mad_u32_u16 v27, v41, s21, v1 op_sel:[1,0,0,0]
    ds_read_b128 v[20:23], v28 offset:16
    v_mfma_f32_32x32x16_bf16 v[144:159], v[12:15], v[104:107], v[144:159]
    buffer_load_dwordx4 v[104:107], v27, s[4:7], 0 offen
    s_waitcnt vmcnt(14) lgkmcnt(4)
    v_perm_b32 v12, v25, v24, v8
    v_perm_b32 v13, v25, v24, v9
    v_perm_b32 v14, v25, v24, v10
    v_perm_b32 v15, v25, v24, v11
    v_mad_u32_u16 v26, v42, s21, v1
    ds_read_b64 v[24:25], v28 offset:32
    v_mfma_f32_32x32x16_bf16 v[160:175], v[12:15], v[108:111], v[160:175]
    buffer_load_dwordx4 v[108:111], v26, s[4:7], 0 offen
    v_mov_b32 v28, v5
    s_cbranch_scc0 L_stub8
L_blk9:
    s_waitcnt lgkmcnt(3)
    v_add_u32 v5, v4, v2
    ds_read_b96 v[36:38], v5 offset:48
    ds_read_b32 v4, v3 offset:6036
    s_waitcnt vmcnt(14) lgkmcnt(4)
    v_perm_b32 v12, v17, v16, v8
    v_perm_b32 v13, v17, v16, v9
    v_perm_b32 v14, v17, v16, v10
    v_perm_b32 v15, v17, v16, v11
    v_mad_u32_u16 v26, v32, s21, v1
    s_add_u32 s22, s22, 1
    v_mfma_f32_32x32x16_bf16 v[176:191], v[12:15], v[52:55], v[176:191]
    buffer_load_dwordx4 v[52:55], v26, s[4:7], 0 offen
    s_waitcnt vmcnt(14)
    v_perm_b32 v12, v19, v18, v8
    v_perm_b32 v13, v19, v18, v9
    v_perm_b32 v14, v19, v18, v10
    v_perm_b32 v15, v19, v18, v11
    v_mad_u32_u16 v27, v32, s21, v1 op_sel:[1,0,0,0]
    ds_read_b128 v[16:19], v29
    v_mfma_f32_32x32x16_bf16 v[192:207], v[12:15], v[56:59], v[192:207]
    buffer_load_dwordx4 v[56:59], v27, s[4:7], 0 offen
    s_waitcnt vmcnt(14) lgkmcnt(4)
    v_perm_b32 v12, v21, v20, v8
    v_perm_b32 v13, v21, v20, v9
    v_perm_b32 v14, v21, v20, v10
    v_perm_b32 v15, v21, v20, v11
    v_mad_u32_u16 v26, v33, s21, v1
    s_cmp_lt_u32 s22, s23
    v_mfma_f32_32x32x16_bf16 v[208:223], v[12:15], v[60:63], v[208:223]
    buffer_load_dwordx4 v[60:63], v26, s[4:7], 0 offen
    s_waitcnt vmcnt(14)
    v_perm_b32 v12, v23, v22, v8
    v_perm_b32 v13, v23, v22, v9
    v_perm_b32 v14, v23, v22, v10
    v_perm_b32 v15, v23, v22, v11
    v_mad_u32_u16 v27, v33, s21, v1 op_sel:[1,0,0,0]
    ds_read_b128 v[20:23], v29 offset:16
    v_mfma_f32_32x32x16_bf16 v[224:239], v[12:15], v[64:67], v[224:239]
    buffer_load_dwordx4 v[64:67], v27, s[4:7], 0 offen
    s_waitcnt vmcnt(14) lgkmcnt(4)
    v_perm_b32 v12, v25, v24, v8
    v_perm_b32 v13, v25, v24, v9
    v_perm_b32 v14, v25, v24, v10
    v_perm_b32 v15, v25, v24, v11
    v_mad_u32_u16 v26, v34, s21, v1
    ds_read_b64 v[24:25], v29 offset:32
    v_mfma_f32_32x32x16_bf16 v[240:255], v[12:15], v[68:71], v[240:255]
    buffer_load_dwordx4 v[68:71], v26, s[4:7], 0 offen
    v_mov_b32 v29, v5
    s_cbranch_scc0 L_exit
L_blk10:
    s_waitcnt lgkmcnt(3)
    v_add_u32 v5, v4, v2
    ds_read_b96 v[40:42], v5 offset:48
    ds_read_b32 v4, v3 offset:6040
    s_waitcnt vmcnt(14) lgkmcnt(4)
    v_perm_b32 v12, v17, v16, v8
    v_perm_b32 v13, v17, v16, v9
    v_perm_b32 v14, v17, v16, v10
    v_perm_b32 v15, v17, v16, v11
    v_mad_u32_u16 v26, v36, s21, v1
    s_bitcmp1_b64 s[26:27], s22
    v_mfma_f32_32x32x16_bf16 a[0:15], v[12:15], v[72:75], a[0:15]
    buffer_load_dwordx4 v[72:75], v26, s[4:7], 0 offen
    s_waitcnt vmcnt(14)
    v_perm_b32 v12, v19, v18, v8
    v_perm_b32 v13, v19, v18, v9
    v_perm_b32 v14, v19, v18, v10
    v_perm_b32 v15, v19, v18, v11
    v_mad_u32_u16 v27, v36, s21, v1 op_sel:[1,0,0,0]
    ds_read_b128 v[16:19], v30
    v_mfma_f32_32x32x16_bf16 a[16:31], v[12:15], v[76:79], a[16:31]
    buffer_load_dwordx4 v[76:79], v27, s[4:7], 0 offen
    s_waitcnt vmcnt(14) lgkmcnt(4)
    v_perm_b32 v12, v21, v20, v8
    v_perm_b32 v13, v21, v20, v9
    v_perm_b32 v14, v21, v20, v10
    v_perm_b32 v15, v21, v20, v11
    v_mad_u32_u16 v26, v37, s21, v1
    s_nop 0
    v_mfma_f32_32x32x16_bf16 a[32:47], v[12:15], v[80:83], a[32:47]
    buffer_load_dwordx4 v[80:83], v26, s[4:7], 0 offen
    s_waitcnt vmcnt(14)
    v_perm_b32 v12, v23, v22, v8
    v_perm_b32 v13, v23, v22, v9
    v_perm_b32 v14, v23, v22, v10
    v_perm_b32 v15, v23, v22, v11
    v_mad_u32_u16 v27, v37, s21, v1 op_sel:[1,0,0,0]
    ds_read_b128 v[20:23], v30 offset:16
    v_mfma_f32_32x32x16_bf16 a[48:63], v[12:15], v[84:87], a[48:63]
    buffer_load_dwordx4 v[84:87], v27, s[4:7], 0 offen
    s_waitcnt vmcnt(14) lgkmcnt(4)
    v_perm_b32 v12, v25, v24, v8
    v_perm_b32 v13, v25, v24, v9
    v_perm_b32 v14, v25, v24, v10
    v_perm_b32 v15, v25, v24, v11
    v_mad_u32_u16 v26, v38, s21, v1
    ds_read_b64 v[24:25], v30 offset:32
    v_mfma_f32_32x32x16_bf16 a[64:79], v[12:15], v[88:91], a[64:79]
    buffer_load_dwordx4 v[88:91], v26, s[4:7], 0 offen
    v_mov_b32 v30, v5
    s_cbranch_scc0 L_stub10
L_blk11:
    s_waitcnt lgkmcnt(3)
    v_add_u32 v5, v4, v2
    ds_read_b96 v[32:34], v5 offset:48
    ds_read_b32 v4, v3 offset:6044
    s_waitcnt vmcnt(14) lgkmcnt(4)
    v_perm_b32 v12, v17, v16, v8
    v_perm_b32 v13, v17, v16, v9
    v_perm_b32 v14, v17, v16, v10
    v_perm_b32 v15, v17, v16, v11
    v_mad_u32_u16 v26, v40, s21, v1
    s_bitcmp1_b64 s[28:29], s22
    v_mfma_f32_32x32x16_bf16 a[80:95], v[12:15], v[92:95], a[80:95]
    buffer_load_dwordx4 v[92:95], v26, s[4:7], 0 offen
    s_waitcnt vmcnt(14)
    v_perm_b32 v12, v19, v18, v8
    v_perm_b32 v13, v19, v18, v9
    v_perm_b32 v14, v19, v18, v10
    v_perm_b32 v15, v19, v18, v11
    v_mad_u32_u16 v27, v40, s21, v1 op_sel:[1,0,0,0]
    ds_read_b128 v[16:19], v28
    v_mfma_f32_32x32x16_bf16 a[96:111], v[12:15], v[96:99], a[96:111]
    buffer_load_dwordx4 v[96:99], v27, s[4:7], 0 offen
    s_waitcnt vmcnt(14) lgkmcnt(4)
    v_perm_b32 v12, v21, v20, v8
    v_perm_b32 v13, v21, v20, v9
    v_perm_b32 v14, v21, v20, v10
    v_perm_b32 v15, v21, v20, v11
    v_mad_u32_u16 v26, v41, s21, v1
    v_add_u32 v3, 12, v3
    v_mfma_f32_32x32x16_bf16 a[112:127], v[12:15], v[100:103], a[112:127]
    buffer_load_dwordx4 v[100:103], v26, s[4:7], 0 offen
    s_waitcnt vmcnt(14)
    v_perm_b32 v12, v23, v22, v8
    v_perm_b32 v13, v23, v22, v9
    v_perm_b32 v14, v23, v22, v10
    v_perm_b32 v15, v23, v22, v11
    v_mad_u32_u16 v27, v41, s21, v1 op_sel:[1,0,0,0]
    ds_read_b128 v[20:23], v28 offset:16
    v_mfma_f32_32x32x16_bf16 a[128:143], v[12:15], v[104:107], a[128:143]
    buffer_load_dwordx4 v[104:107], v27, s[4:7], 0 offen
    s_waitcnt vmcnt(14) lgkmcnt(4)
    v_perm_b32 v12, v25, v24, v8
    v_perm_b32 v13, v25, v24, v9
    v_perm_b32 v14, v25, v24, v10
    v_perm_b32 v15, v25, v24, v11
    v_mad_u32_u16 v26, v42, s21, v1
    ds_read_b64 v[24:25], v28 offset:32
    v_mfma_f32_32x32x16_bf16 a[144:159], v[12:15], v[108:111], a[144:159]
    buffer_load_dwordx4 v[108:111], v26, s[4:7], 0 offen
    v_mov_b32 v28, v5
    s_cbranch_scc0 L_stub11
L_blk12:
    s_waitcnt lgkmcnt(3)
    v_add_u32 v5, v4, v2
    ds_read_b96 v[36:38], v5 offset:48
    ds_read_b32 v4, v3 offset:6036
    s_waitcnt vmcnt(14) lgkmcnt(4)
    v_perm_b32 v12, v17, v16, v8
    v_perm_b32 v13, v17, v16, v9
    v_perm_b32 v14, v17, v16, v10
    v_perm_b32 v15, v17, v16, v11
    v_mad_u32_u16 v26, v32, s21, v1
    s_bitcmp1_b64 s[30:31], s22
    v_mfma_f32_32x32x16_bf16 a[160:175], v[12:15], v[52:55], a[160:175]
    buffer_load_dwordx4 v[52:55], v26, s[4:7], 0 offen
    s_waitcnt vmcnt(14)
    v_perm_b32 v12, v19, v18, v8
    v_perm_b32 v13, v19, v18, v9
    v_perm_b32 v14, v19, v18, v10
    v_perm_b32 v15, v19, v18, v11
    v_mad_u32_u16 v27, v32, s21, v1 op_sel:[1,0,0,0]
    ds_read_b128 v[16:19], v29
    v_mfma_f32_32x32x16_bf16 a[176:191], v[12:15], v[56:59], a[176:191]
    buffer_load_dwordx4 v[56:59], v27, s[4:7], 0 offen
    s_waitcnt vmcnt(14) lgkmcnt(4)
    v_perm_b32 v12, v21, v20, v8
    v_perm_b32 v13, v21, v20, v9
    v_perm_b32 v14, v21, v20, v10
    v_perm_b32 v15, v21, v20, v11
    v_mad_u32_u16 v26, v33, s21, v1
    s_nop 0
    v_mfma_f32_32x32x16_bf16 a[192:207], v[12:15], v[60:63], a[192:207]
    buffer_load_dwordx4 v[60:63], v26, s[4:7], 0 offen
    s_waitcnt vmcnt(14)
    v_perm_b32 v12, v23, v22, v8
    v_perm_b32 v13, v23, v22, v9
    v_perm_b32 v14, v23, v22, v10
    v_perm_b32 v15, v23, v22, v11
    v_mad_u32_u16 v27, v33, s21, v1 op_sel:[1,0,0,0]
    ds_read_b128 v[20:23], v29 offset:16
    v_mfma_f32_32x32x16_bf16 a[208:223], v[12:15], v[64:67], a[208:223]
    buffer_load_dwordx4 v[64:67], v27, s[4:7], 0 offen
    s_waitcnt vmcnt(14) lgkmcnt(4)
    v_perm_b32 v12, v25, v24, v8
    v_perm_b32 v13, v25, v24, v9
    v_perm_b32 v14, v25, v24, v10
    v_perm_b32 v15, v25, v24, v11
    v_mad_u32_u16 v26, v34, s21, v1
    ds_read_b64 v[24:25], v29 offset:32
    v_mfma_f32_32x32x16_bf16 a[224:239], v[12:15], v[68:71], a[224:239]
    buffer_load_dwordx4 v[68:71], v26, s[4:7], 0 offen
    v_mov_b32 v29, v5
    s_cbranch_scc0 L_stub12
L_blk13:
    s_waitcnt lgkmcnt(3)
    v_add_u32 v5, v4, v2
    ds_read_b96 v[40:42], v5 offset:48
    ds_read_b32 v4, v3 offset:6040
    s_waitcnt vmcnt(14) lgkmcnt(4)
    v_perm_b32 v12, v17, v16, v8
    v_perm_b32 v13, v17, v16, v9
    v_perm_b32 v14, v17, v16, v10
    v_perm_b32 v15, v17, v16, v11
    v_mad_u32_u16 v26, v36, s21, v1
    s_bitcmp1_b64 s[32:33], s22
    v_mfma_f32_32x32x16_bf16 a[240:255], v[12:15], v[72:75], a[240:255]
    buffer_load_dwordx4 v[72:75], v26, s[4:7], 0 offen
    s_waitcnt vmcnt(14)
    v_perm_b32 v12, v19, v18, v8
    v_perm_b32 v13, v19, v18, v9
    v_perm_b32 v14, v19, v18, v10
    v_perm_b32 v15, v19, v18, v11
    v_mad_u32_u16 v27, v36, s21, v1 op_sel:[1,0,0,0]
    ds_read_b128 v[16:19], v30
    v_mfma_f32_32x32x16_bf16 v[112:127], v[12:15], v[76:79], v[112:127]
    buffer_load_dwordx4 v[76:79], v27, s[4:7], 0 offen
    s_waitcnt vmcnt(14) lgkmcnt(4)
    v_perm_b32 v12, v21, v20, v8
    v_perm_b32 v13, v21, v20, v9
    v_perm_b32 v14, v21, v20, v10
    v_perm_b32 v15, v21, v20, v11
    v_mad_u32_u16 v26, v37, s21, v1
    s_nop 0
    v_mfma_f32_32x32x16_bf16 v[128:143], v[12:15], v[80:83], v[128:143]
    buffer_load_dwordx4 v[80:83], v26, s[4:7], 0 offen
    s_waitcnt vmcnt(14)
    v_perm_b32 v12, v23, v22, v8
    v_perm_b32 v13, v23, v22, v9
    v_perm_b32 v14, v23, v22, v10
    v_perm_b32 v15, v23, v22, v11
    v_mad_u32_u16 v27, v37, s21, v1 op_sel:[1,0,0,0]
    ds_read_b128 v[20:23], v30 offset:16
    v_mfma_f32_32x32x16_bf16 v[144:159], v[12:15], v[84:87], v[144:159]
    buffer_load_dwordx4 v[84:87], v27, s[4:7], 0 offen
    s_waitcnt vmcnt(14) lgkmcnt(4)
    v_perm_b32 v12, v25, v24, v8
    v_perm_b32 v13, v25, v24, v9
    v_perm_b32 v14, v25, v24, v10
    v_perm_b32 v15, v25, v24, v11
    v_mad_u32_u16 v26, v38, s21, v1
    ds_read_b64 v[24:25], v30 offset:32
    v_mfma_f32_32x32x16_bf16 v[160:175], v[12:15], v[88:91], v[160:175]
    buffer_load_dwordx4 v[88:91], v26, s[4:7], 0 offen
    v_mov_b32 v30, v5
    s_cbranch_scc0 L_stub13
L_blk14:
    s_waitcnt lgkmcnt(3)
    v_add_u32 v5, v4, v2
    ds_read_b96 v[32:34], v5 offset:48
    ds_read_b32 v4, v3 offset:6044
    s_waitcnt vmcnt(14) lgkmcnt(4)
    v_perm_b32 v12, v17, v16, v8
    v_perm_b32 v13, v17, v16, v9
    v_perm_b32 v14, v17, v16, v10
    v_perm_b32 v15, v17, v16, v11
    v_mad_u32_u16 v26, v40, s21, v1
    s_add_u32 s22, s22, 1
    v_mfma_f32_32x32x16_bf16 v[176:191], v[12:15], v[92:95], v[176:191]
    buffer_load_dwordx4 v[92:95], v26, s[4:7], 0 offen
    s_waitcnt vmcnt(14)
    v_perm_b32 v12, v19, v18, v8
    v_perm_b32 v13, v19, v18, v9
    v_perm_b32 v14, v19, v18, v10
    v_perm_b32 v15, v19, v18, v11
    v_mad_u32_u16 v27, v40, s21, v1 op_sel:[1,0,0,0]
    ds_read_b128 v[16:19], v28
    v_mfma_f32_32x32x16_bf16 v[192:207], v[12:15], v[96:99], v[192:207]
    buffer_load_dwordx4 v[96:99], v27, s[4:7], 0 offen
    s_waitcnt vmcnt(14) lgkmcnt(4)
    v_perm_b32 v12, v21, v20, v8
    v_perm_b32 v13, v21, v20, v9
    v_perm_b32 v14, v21, v20, v10
    v_perm_b32 v15, v21, v20, v11
    v_mad_u32_u16 v26, v41, s21, v1
    s_cmp_lt_u32 s22, s23
    v_mfma_f32_32x32x16_bf16 v[208:223], v[12:15], v[100:103], v[208:223]
    buffer_load_dwordx4 v[100:103], v26, s[4:7], 0 offen
    s_waitcnt vmcnt(14)
    v_perm_b32 v12, v23, v22, v8
    v_perm_b32 v13, v23, v22, v9
    v_perm_b32 v14, v23, v22, v10
    v_perm_b32 v15, v23, v22, v11
    v_mad_u32_u16 v27, v41, s21, v1 op_sel:[1,0,0,0]
    ds_read_b128 v[20:23], v28 offset:16
    v_mfma_f32_32x32x16_bf16 v[224:239], v[12:15], v[104:107], v[224:239]
    buffer_load_dwordx4 v[104:107], v27, s[4:7], 0 offen
    s_waitcnt vmcnt(14) lgkmcnt(4)
    v_perm_b32 v12, v25, v24, v8
    v_perm_b32 v13, v25, v24, v9
    v_perm_b32 v14, v25, v24, v10
    v_perm_b32 v15, v25, v24, v11
    v_mad_u32_u16 v26, v42, s21, v1
    ds_read_b64 v[24:25], v28 offset:32
    v_mfma_f32_32x32x16_bf16 v[240:255], v[12:15], v[108:111], v[240:255]
    buffer_load_dwordx4 v[108:111], v26, s[4:7], 0 offen
    v_mov_b32 v28, v5
    v_add_u32 v3, 12, v3
    s_cbranch_scc0 L_exit
    s_branch L_blk0
L_stub0:
    s_bitcmp1_b64 s[28:29], s22
    s_cbranch_scc1 L_blk7
    s_bitcmp1_b64 s[30:31], s22
    s_cbranch_scc1 L_blk13
    s_bitcmp1_b64 s[32:33], s22
    s_cbranch_scc1 L_blk4
    s_add_u32 s22, s22, 1
    s_cmp_lt_u32 s22, s23
    s_cbranch_scc1 L_blk10
    s_branch L_exit
L_stub1:
    s_bitcmp1_b64 s[30:31], s22
    s_cbranch_scc1 L_blk8
    s_bitcmp1_b64 s[32:33], s22
    s_cbranch_scc1 L_blk14
    s_add_u32 s22, s22, 1
    s_cmp_lt_u32 s22, s23
    s_cbranch_scc1 L_blk5
    s_branch L_exit
L_stub2:
    s_bitcmp1_b64 s[32:33], s22
    s_cbranch_scc1 L_blk9
    s_add_u32 s22, s22, 1
    s_cmp_lt_u32 s22, s23
    s_cbranch_scc1 L_blk0
    s_branch L_exit
L_stub3:
    s_add_u32 s22, s22, 1
    s_cmp_lt_u32 s22, s23
    s_cbranch_scc1 L_blk10
    s_branch L_exit
L_stub5:
    s_bitcmp1_b64 s[28:29], s22
    s_cbranch_scc1 L_blk12
    s_bitcmp1_b64 s[30:31], s22
    s_cbranch_scc1 L_blk3
    s_bitcmp1_b64 s[32:33], s22
    s_cbranch_scc1 L_blk9
    s_add_u32 s22, s22, 1
    s_cmp_lt_u32 s22, s23
    s_cbranch_scc1 L_blk0
    s_branch L_exit
L_stub6:
    s_bitcmp1_b64 s[30:31], s22
    s_cbranch_scc1 L_blk13
    s_bitcmp1_b64 s[32:33], s22
    s_cbranch_scc1 L_blk4
    s_add_u32 s22, s22, 1
    s_cmp_lt_u32 s22, s23
    s_cbranch_scc1 L_blk10
    s_branch L_exit
L_stub7:
    s_bitcmp1_b64 s[32:33], s22
    s_cbranch_scc1 L_blk14
    s_add_u32 s22, s22, 1
    s_cmp_lt_u32 s22, s23
    s_cbranch_scc1 L_blk5
    s_branch L_exit
L_stub8:
    s_add_u32 s22, s22, 1
    s_cmp_lt_u32 s22, s23
    s_cbranch_scc1 L_blk0
    s_branch L_exit
L_stub10:
    s_bitcmp1_b64 s[28:29], s22
    s_cbranch_scc1 L_blk2
    s_bitcmp1_b64 s[30:31], s22
    s_cbranch_scc1 L_blk8
    s_bitcmp1_b64 s[32:33], s22
    s_cbranch_scc1 L_blk14
    s_add_u32 s22, s22, 1
    s_cmp_lt_u32 s22, s23
    s_cbranch_scc1 L_blk5
    s_branch L_exit
L_stub11:
    s_bitcmp1_b64 s[30:31], s22
    s_cbranch_scc1 L_blk3
    s_bitcmp1_b64 s[32:33], s22
    s_cbranch_scc1 L_blk9
    s_add_u32 s22, s22, 1
    s_cmp_lt_u32 s22, s23
    s_cbranch_scc1 L_blk0
    s_branch L_exit
L_stub12:
    s_bitcmp1_b64 s[32:33], s22
    s_cbranch_scc1 L_blk4
    s_add_u32 s22, s22, 1
    s_cmp_lt_u32 s22, s23
    s_cbranch_scc1 L_blk10
    s_branch L_exit
L_stub13:
    s_add_u32 s22, s22, 1
    s_cmp_lt_u32 s22, s23
    s_cbranch_scc1 L_blk5
L_exit:
    s_waitcnt lgkmcnt(0)
    s_cmp_eq_u32 s82, 0
    s_cbranch_scc0 L_next_batch
L_epi:
    v_mov_b32 v1, v44
    v_mov_b32 v2, v45
    v_mov_b32 v3, v46
    v_mov_b32 v4, v47
    v_mov_b32 v5, v48
    s_nop 3
    v_cvt_pk_bf16_f32 v20, v112, v113
    v_cvt_pk_bf16_f32 v21, v114, v115
    v_cvt_pk_bf16_f32 v22, v128, v129
    v_cvt_pk_bf16_f32 v23, v130, v131
    v_cvt_pk_bf16_f32 v24, v144, v145
    v_cvt_pk_bf16_f32 v25, v146, v147
    ds_write_b64 v1, v[20:21] offset:16640
    v_cvt_pk_bf16_f32 v26, v160, v161
    v_cvt_pk_bf16_f32 v27, v162, v163
    ds_write_b64 v1, v[22:23] offset:17680
    v_cvt_pk_bf16_f32 v28, v176, v177
    v_cvt_pk_bf16_f32 v29, v178, v179
    ds_write_b64 v1, v[24:25] offset:18720
    v_cvt_pk_bf16_f32 v30, v192, v193
    v_cvt_pk_bf16_f32 v31, v194, v195
    ds_write_b64 v1, v[26:27] offset:19760
    v_cvt_pk_bf16_f32 v20, v208, v209
    v_cvt_pk_bf16_f32 v21, v210, v211
    ds_write_b64 v1, v[28:29] offset:20800
    v_cvt_pk_bf16_f32 v22, v224, v225
    v_cvt_pk_bf16_f32 v23, v226, v227
    ds_write_b64 v1, v[30:31] offset:21840
    v_cvt_pk_bf16_f32 v24, v240, v241
    v_cvt_pk_bf16_f32 v25, v242, v243
    ds_write_b64 v1, v[20:21] offset:22880
    ds_write_b64 v1, v[22:23] offset:23920
    ds_write_b64 v1, v[24:25] offset:24960
    v_accvgpr_read_b32 v24, a0
    v_accvgpr_read_b32 v25, a1
    v_accvgpr_read_b32 v26, a2
    v_accvgpr_read_b32 v27, a3
    v_accvgpr_read_b32 v28, a16
    v_accvgpr_read_b32 v29, a17
    v_cvt_pk_bf16_f32 v24, v24, v25
    v_accvgpr_read_b32 v30, a18
    v_accvgpr_read_b32 v31, a19
    v_cvt_pk_bf16_f32 v25, v26, v27
    v_accvgpr_read_b32 v20, a32
    v_accvgpr_read_b32 v21, a33
    ds_write_b64 v1, v[24:25] offset:0
    v_cvt_pk_bf16_f32 v28, v28, v29
    v_accvgpr_read_b32 v22, a34
    v_accvgpr_read_b32 v23, a35
    v_cvt_pk_bf16_f32 v29, v30, v31
    v_accvgpr_read_b32 v24, a48
    v_accvgpr_read_b32 v25, a49
    ds_write_b64 v1, v[28:29] offset:1040
    v_cvt_pk_bf16_f32 v20, v20, v21
    v_accvgpr_read_b32 v26, a50
    v_accvgpr_read_b32 v27, a51
    v_cvt_pk_bf16_f32 v21, v22, v23
    v_accvgpr_read_b32 v28, a64
    v_accvgpr_read_b32 v29, a65
    ds_write_b64 v1, v[20:21] offset:2080
    v_cvt_pk_bf16_f32 v24, v24, v25
    v_accvgpr_read_b32 v30, a66
    v_accvgpr_read_b32 v31, a67
    v_cvt_pk_bf16_f32 v25, v26, v27
    v_accvgpr_read_b32 v20, a80
    v_accvgpr_read_b32 v21, a81
    ds_write_b64 v1, v[24:25] offset:3120
    v_cvt_pk_bf16_f32 v28, v28, v29
    v_accvgpr_read_b32 v22, a82
    v_accvgpr_read_b32 v23, a83
    v_cvt_pk_bf16_f32 v29, v30, v31
    v_accvgpr_read_b32 v24, a96
    v_accvgpr_read_b32 v25, a97
    ds_write_b64 v1, v[28:29] offset:4160
    v_cvt_pk_bf16_f32 v20, v20, v21
    v_accvgpr_read_b32 v26, a98
    v_accvgpr_read_b32 v27, a99
    v_cvt_pk_bf16_f32 v21, v22, v23
    v_accvgpr_read_b32 v28, a112
    v_accvgpr_read_b32 v29, a113
    ds_write_b64 v1, v[20:21] offset:5200
    v_cvt_pk_bf16_f32 v24, v24, v25
    v_accvgpr_read_b32 v30, a114
    v_accvgpr_read_b32 v31, a115
    v_cvt_pk_bf16_f32 v25, v26, v27
    v_accvgpr_read_b32 v20, a128
    v_accvgpr_read_b32 v21, a129
    ds_write_b64 v1, v[24:25] offset:6240
    v_cvt_pk_bf16_f32 v28, v28, v29
    v_accvgpr_read_b32 v22, a130
    v_accvgpr_read_b32 v23, a131
    v_cvt_pk_bf16_f32 v29, v30, v31
    v_accvgpr_read_b32 v24, a144
    v_accvgpr_read_b32 v25, a145
    ds_write_b64 v1, v[28:29] offset:7280
    v_cvt_pk_bf16_f32 v20, v20, v21
    v_accvgpr_read_b32 v26, a146
    v_accvgpr_read_b32 v27, a147
    v_cvt_pk_bf16_f32 v21, v22, v23
    v_accvgpr_read_b32 v28, a160
    v_accvgpr_read_b32 v29, a161
    ds_write_b64 v1, v[20:21] offset:8320
    v_cvt_pk_bf16_f32 v24, v24, v25
    v_accvgpr_read_b32 v30, a162
    v_accvgpr_read_b32 v31, a163
    v_cvt_pk_bf16_f32 v25, v26, v27
    v_accvgpr_read_b32 v20, a176
    v_accvgpr_read_b32 v21, a177
    ds_write_b64 v1, v[24:25] offset:9360
    v_cvt_pk_bf16_f32 v28, v28, v29
    v_accvgpr_read_b32 v22, a178
    v_accvgpr_read_b32 v23, a179
    v_cvt_pk_bf16_f32 v29, v30, v31
    v_accvgpr_read_b32 v24, a192
    v_accvgpr_read_b32 v25, a193
    ds_write_b64 v1, v[28:29] offset:10400
    v_cvt_pk_bf16_f32 v20, v20, v21
    v_accvgpr_read_b32 v26, a194
    v_accvgpr_read_b32 v27, a195
    v_cvt_pk_bf16_f32 v21, v22, v23
    v_accvgpr_read_b32 v28, a208
    v_accvgpr_read_b32 v29, a209
    ds_write_b64 v1, v[20:21] offset:11440
    v_cvt_pk_bf16_f32 v24, v24, v25
    v_accvgpr_read_b32 v30, a210
    v_accvgpr_read_b32 v31, a211
    v_cvt_pk_bf16_f32 v25, v26, v27
    v_accvgpr_read_b32 v20, a224
    v_accvgpr_read_b32 v21, a225
    ds_write_b64 v1, v[24:25] offset:12480
    v_cvt_pk_bf16_f32 v28, v28, v29
    v_accvgpr_read_b32 v22, a226
    v_accvgpr_read_b32 v23, a227
    v_cvt_pk_bf16_f32 v29, v30, v31
    v_accvgpr_read_b32 v24, a240
    v_accvgpr_read_b32 v25, a241
    ds_write_b64 v1, v[28:29] offset:13520
    v_cvt_pk_bf16_f32 v20, v20, v21
    v_accvgpr_read_b32 v26, a242
    v_accvgpr_read_b32 v27, a243
    v_cvt_pk_bf16_f32 v21, v22, v23
    ds_write_b64 v1, v[20:21] offset:14560
    v_cvt_pk_bf16_f32 v24, v24, v25
    v_cvt_pk_bf16_f32 v25, v26, v27
    ds_write_b64 v1, v[24:25] offset:15600
    ds_read_b128 v[8:11], v2 offset:0
    ds_read_b128 a[0:3], v3 offset:9472
    ds_read_b128 a[16:19], v3 offset:10496
    ds_read_b128 v[12:15], v2 offset:32
    ds_read_b128 a[32:35], v3 offset:11520
    ds_read_b128 a[48:51], v3 offset:12544
    s_waitcnt vmcnt(0) lgkmcnt(3)
    v_mfma_f32_32x32x16_bf16 v[32:47], v[8:11], a[0:3], 0
    ds_read_b128 v[16:19], v2 offset:256
    ds_read_b128 a[64:67], v3 offset:13568
    ds_read_b128 a[80:83], v3 offset:14592
    v_cvt_pk_bf16_f32 v114, v116, v117
    v_cvt_pk_bf16_f32 v115, v118, v119
    v_cvt_pk_bf16_f32 v116, v120, v121
    v_cvt_pk_bf16_f32 v117, v122, v123
    v_cvt_pk_bf16_f32 v118, v124, v125
    v_mfma_f32_32x32x16_bf16 v[48:63], v[8:11], a[16:19], 0
    v_cvt_pk_bf16_f32 v119, v126, v127
    v_cvt_pk_bf16_f32 v122, v132, v133
    v_cvt_pk_bf16_f32 v123, v134, v135
    v_cvt_pk_bf16_f32 v124, v136, v137
    v_cvt_pk_bf16_f32 v125, v138, v139
    v_cvt_pk_bf16_f32 v126, v140, v141
    v_cvt_pk_bf16_f32 v127, v142, v143
    s_waitcnt lgkmcnt(3)
    v_mfma_f32_32x32x16_bf16 v[32:47], v[12:15], a[32:35], v[32:47]
    ds_read_b128 v[8:11], v2 offset:288
    ds_read_b128 a[96:99], v3 offset:15616
    ds_read_b128 a[112:115], v3 offset:16640
    v_cvt_pk_bf16_f32 v130, v148, v149
    v_cvt_pk_bf16_f32 v131, v150, v151
    v_cvt_pk_bf16_f32 v132, v152, v153
    v_cvt_pk_bf16_f32 v133, v154, v155
    v_cvt_pk_bf16_f32 v134, v156, v157
    v_mfma_f32_32x32x16_bf16 v[48:63], v[12:15], a[48:51], v[48:63]
    v_cvt_pk_bf16_f32 v135, v158, v159
    v_cvt_pk_bf16_f32 v138, v164, v165
    v_cvt_pk_bf16_f32 v139, v166, v167
    v_cvt_pk_bf16_f32 v140, v168, v169
    v_cvt_pk_bf16_f32 v141, v170, v171
    v_cvt_pk_bf16_f32 v142, v172, v173
    v_cvt_pk_bf16_f32 v143, v174, v175
    s_waitcnt lgkmcnt(3)
    v_mfma_f32_32x32x16_bf16 v[32:47], v[16:19], a[64:67], v[32:47]
    ds_read_b128 v[12:15], v2 offset:64
    ds_read_b128 a[128:131], v3 offset:34048
    ds_read_b128 a[144:147], v3 offset:35072
    v_cvt_pk_bf16_f32 v146, v180, v181
    v_cvt_pk_bf16_f32 v147, v182, v183
    v_cvt_pk_bf16_f32 v148, v184, v185
    v_cvt_pk_bf16_f32 v149, v186, v187
    v_cvt_pk_bf16_f32 v150, v188, v189
    v_mfma_f32_32x32x16_bf16 v[48:63], v[16:19], a[80:83], v[48:63]
    v_cvt_pk_bf16_f32 v151, v190, v191
    v_cvt_pk_bf16_f32 v154, v196, v197
    v_cvt_pk_bf16_f32 v155, v198, v199
    v_cvt_pk_bf16_f32 v156, v200, v201
    v_cvt_pk_bf16_f32 v157, v202, v203
    v_cvt_pk_bf16_f32 v158, v204, v205
    v_cvt_pk_bf16_f32 v159, v206, v207
    s_waitcnt lgkmcnt(3)
    v_mfma_f32_32x32x16_bf16 v[32:47], v[8:11], a[96:99], v[32:47]
    ds_read_b128 v[16:19], v2 offset:96
    ds_read_b128 a[160:163], v3 offset:36096
    ds_read_b128 a[176:179], v3 offset:37120
    v_cvt_pk_bf16_f32 v162, v212, v213
    v_cvt_pk_bf16_f32 v163, v214, v215
    v_cvt_pk_bf16_f32 v164, v216, v217
    v_cvt_pk_bf16_f32 v165, v218, v219
    v_cvt_pk_bf16_f32 v166, v220, v221
    v_mfma_f32_32x32x16_bf16 v[48:63], v[8:11], a[112:115], v[48:63]
    v_cvt_pk_bf16_f32 v167, v222, v223
    v_cvt_pk_bf16_f32 v170, v228, v229
    v_cvt_pk_bf16_f32 v171, v230, v231
    v_cvt_pk_bf16_f32 v172, v232, v233
    v_cvt_pk_bf16_f32 v173, v234, v235
    v_cvt_pk_bf16_f32 v174, v236, v237
    v_cvt_pk_bf16_f32 v175, v238, v239
    s_waitcnt lgkmcnt(3)
    v_mfma_f32_32x32x16_bf16 v[64:79], v[12:15], a[128:131], 0
    ds_read_b128 v[8:11], v2 offset:320
    ds_read_b128 a[192:195], v3 offset:38144
    ds_read_b128 a[208:211], v3 offset:39168
    v_cvt_pk_bf16_f32 v178, v244, v245
    v_cvt_pk_bf16_f32 v179, v246, v247
    v_cvt_pk_bf16_f32 v180, v248, v249
    v_cvt_pk_bf16_f32 v181, v250, v251
    v_cvt_pk_bf16_f32 v182, v252, v253
    v_mfma_f32_32x32x16_bf16 v[80:95], v[12:15], a[144:147], 0
    v_cvt_pk_bf16_f32 v183, v254, v255
    v_accvgpr_read_b32 v232, a4
    v_accvgpr_read_b32 v233, a5
    v_accvgpr_read_b32 v234, a6
    v_accvgpr_read_b32 v235, a7
    v_accvgpr_read_b32 v236, a20
    v_accvgpr_read_b32 v237, a21
    s_waitcnt lgkmcnt(3)
    v_mfma_f32_32x32x16_bf16 v[64:79], v[16:19], a[160:163], v[64:79]
    ds_read_b128 v[12:15], v2 offset:352
    ds_read_b128 a[224:227], v3 offset:40192
    ds_read_b128 a[240:243], v3 offset:41216
    v_cvt_pk_bf16_f32 v232, v232, v233
    v_accvgpr_read_b32 v238, a22
    v_accvgpr_read_b32 v239, a23
    v_cvt_pk_bf16_f32 v233, v234, v235
    v_accvgpr_read_b32 v24, a36
    v_mfma_f32_32x32x16_bf16 v[80:95], v[16:19], a[176:179], v[80:95]
    v_accvgpr_read_b32 v25, a37
    ds_write_b64 v1, v[232:233] offset:512
    v_cvt_pk_bf16_f32 v236, v236, v237
    v_accvgpr_read_b32 v26, a38
    v_accvgpr_read_b32 v27, a39
    v_cvt_pk_bf16_f32 v237, v238, v239
    v_accvgpr_read_b32 v28, a52
    s_waitcnt lgkmcnt(4)
    v_mfma_f32_32x32x16_bf16 v[64:79], v[8:11], a[192:195], v[64:79]
    ds_read_b128 v[16:19], v2 offset:128
    v_accvgpr_read_b32 v29, a53
    ds_write_b64 v1, v[236:237] offset:1552
    v_cvt_pk_bf16_f32 v24, v24, v25
    v_accvgpr_read_b32 v30, a54
    v_accvgpr_read_b32 v31, a55
    v_cvt_pk_bf16_f32 v25, v26, v27
    v_accvgpr_read_b32 v232, a68
    v_mfma_f32_32x32x16_bf16 v[80:95], v[8:11], a[208:211], v[80:95]
    v_accvgpr_read_b32 v233, a69
    ds_write_b64 v1, v[24:25] offset:2592
    v_cvt_pk_bf16_f32 v28, v28, v29
    v_accvgpr_read_b32 v234, a70
    v_accvgpr_read_b32 v235, a71
    v_cvt_pk_bf16_f32 v29, v30, v31
    v_accvgpr_read_b32 v236, a84
    s_waitcnt lgkmcnt(4)
    v_mfma_f32_32x32x16_bf16 v[64:79], v[12:15], a[224:227], v[64:79]
    ds_read_b128 v[8:11], v2 offset:160
    v_accvgpr_read_b32 v237, a85
    ds_write_b64 v1, v[28:29] offset:3632
    v_cvt_pk_bf16_f32 v232, v232, v233
    v_accvgpr_read_b32 v238, a86
    v_accvgpr_read_b32 v239, a87
    v_cvt_pk_bf16_f32 v233, v234, v235
    v_accvgpr_read_b32 v24, a100
    v_mfma_f32_32x32x16_bf16 v[80:95], v[12:15], a[240:243], v[80:95]
    v_accvgpr_read_b32 v25, a101
    ds_write_b64 v1, v[232:233] offset:4672
    v_cvt_pk_bf16_f32 v236, v236, v237
    v_accvgpr_read_b32 v26, a102
    v_accvgpr_read_b32 v27, a103
    v_cvt_pk_bf16_f32 v237, v238, v239
    v_accvgpr_read_b32 v28, a116
    s_waitcnt lgkmcnt(5)
    v_mfma_f32_32x32x16_bf16 v[96:111], v[16:19], a[128:131], 0
    ds_read_b128 v[12:15], v2 offset:384
    v_accvgpr_read_b32 v29, a117
    ds_write_b64 v1, v[236:237] offset:5712
    v_cvt_pk_bf16_f32 v24, v24, v25
    v_accvgpr_read_b32 v30, a118
    v_accvgpr_read_b32 v31, a119
    v_cvt_pk_bf16_f32 v25, v26, v27
    v_mfma_f32_32x32x16_bf16 v[184:199], v[16:19], a[144:147], 0
    v_accvgpr_read_b32 v232, a132
    v_accvgpr_read_b32 v233, a133
    ds_write_b64 v1, v[24:25] offset:6752
    v_cvt_pk_bf16_f32 v28, v28, v29
    v_accvgpr_read_b32 v234, a134
    v_accvgpr_read_b32 v235, a135
    v_cvt_pk_bf16_f32 v29, v30, v31
    s_waitcnt lgkmcnt(5)
    v_mfma_f32_32x32x16_bf16 v[96:111], v[8:11], a[160:163], v[96:111]
    ds_read_b128 v[16:19], v2 offset:416
    v_accvgpr_read_b32 v236, a148
    v_accvgpr_read_b32 v237, a149
    ds_write_b64 v1, v[28:29] offset:7792
    v_cvt_pk_bf16_f32 v232, v232, v233
    v_accvgpr_read_b32 v238, a150
    v_accvgpr_read_b32 v239, a151
    v_mfma_f32_32x32x16_bf16 v[184:199], v[8:11], a[176:179], v[184:199]
    ds_write_b64 v1, v[114:115] offset:17152
    v_cvt_pk_bf16_f32 v233, v234, v235
    v_accvgpr_read_b32 v24, a164
    v_accvgpr_read_b32 v25, a165
    ds_write_b64 v1, v[232:233] offset:8832
    v_cvt_pk_bf16_f32 v236, v236, v237
    s_waitcnt lgkmcnt(6)
    v_mfma_f32_32x32x16_bf16 v[96:111], v[12:15], a[192:195], v[96:111]
    ds_read_b128 v[8:11], v2 offset:192
    v_accvgpr_read_b32 v26, a166
    v_accvgpr_read_b32 v27, a167
    ds_write_b64 v1, v[122:123] offset:18192
    v_cvt_pk_bf16_f32 v237, v238, v239
    v_accvgpr_read_b32 v28, a180
    v_accvgpr_read_b32 v29, a181
    v_mfma_f32_32x32x16_bf16 v[184:199], v[12:15], a[208:211], v[184:199]
    ds_write_b64 v1, v[236:237] offset:9872
    v_cvt_pk_bf16_f32 v24, v24, v25
    v_accvgpr_read_b32 v30, a182
    v_accvgpr_read_b32 v31, a183
    ds_write_b64 v1, v[130:131] offset:19232
    v_cvt_pk_bf16_f32 v25, v26, v27
    s_waitcnt lgkmcnt(7)
    v_mfma_f32_32x32x16_bf16 v[96:111], v[16:19], a[224:227], v[96:111]
    ds_read_b128 v[12:15], v2 offset:224
    v_accvgpr_read_b32 v232, a196
    v_accvgpr_read_b32 v233, a197
    ds_write_b64 v1, v[24:25] offset:10912
    v_cvt_pk_bf16_f32 v28, v28, v29
    v_accvgpr_read_b32 v234, a198
    v_accvgpr_read_b32 v235, a199
    ds_write_b64 v1, v[138:139] offset:20272
    v_mfma_f32_32x32x16_bf16 v[184:199], v[16:19], a[240:243], v[184:199]
    v_cvt_pk_bf16_f32 v29, v30, v31
    v_accvgpr_read_b32 v236, a212
    v_accvgpr_read_b32 v237, a213
    ds_write_b64 v1, v[28:29] offset:11952
    v_cvt_pk_bf16_f32 v232, v232, v233
    v_accvgpr_read_b32 v238, a214
    v_accvgpr_read_b32 v239, a215
    s_waitcnt lgkmcnt(7)
    v_mfma_f32_32x32x16_bf16 v[200:215], v[8:11], a[128:131], 0
    ds_read_b128 v[16:19], v2 offset:448
    ds_write_b64 v1, v[146:147] offset:21312
    v_cvt_pk_bf16_f32 v233, v234, v235
    v_accvgpr_read_b32 v24, a228
    v_accvgpr_read_b32 v25, a229
    ds_write_b64 v1, v[232:233] offset:12992
    v_cvt_pk_bf16_f32 v236, v236, v237
    v_mfma_f32_32x32x16_bf16 v[216:231], v[8:11], a[144:147], 0
    v_accvgpr_read_b32 v26, a230
    v_accvgpr_read_b32 v27, a231
    ds_write_b64 v1, v[154:155] offset:22352
    v_cvt_pk_bf16_f32 v237, v238, v239
    v_accvgpr_read_b32 v28, a244
    v_accvgpr_read_b32 v29, a245
    ds_write_b64 v1, v[236:237] offset:14032
    s_waitcnt lgkmcnt(8)
    v_mfma_f32_32x32x16_bf16 v[200:215], v[12:15], a[160:163], v[200:215]
    ds_read_b128 v[8:11], v2 offset:480
    v_cvt_pk_bf16_f32 v24, v24, v25
    v_accvgpr_read_b32 v30, a246
    v_accvgpr_read_b32 v31, a247
    ds_write_b64 v1, v[162:163] offset:23392
    v_cvt_pk_bf16_f32 v25, v26, v27
    ds_write_b64 v1, v[24:25] offset:15072
    v_mfma_f32_32x32x16_bf16 v[216:231], v[12:15], a[176:179], v[216:231]
    v_cvt_pk_bf16_f32 v28, v28, v29
    ds_write_b64 v1, v[170:171] offset:24432
    v_cvt_pk_bf16_f32 v29, v30, v31
    ds_write_b64 v1, v[28:29] offset:16112
    ds_write_b64 v1, v[178:179] offset:25472
    s_waitcnt lgkmcnt(10)
    v_mfma_f32_32x32x16_bf16 v[200:215], v[16:19], a[192:195], v[200:215]
    ds_read_b128 v[12:15], v2 offset:512
    ds_read_b128 a[4:7], v3 offset:25856
    ds_read_b128 a[20:23], v3 offset:26880
    v_accvgpr_read_b32 v232, a8
    v_accvgpr_read_b32 v233, a9
    v_accvgpr_read_b32 v234, a10
    v_mfma_f32_32x32x16_bf16 v[216:231], v[16:19], a[208:211], v[216:231]
    v_accvgpr_read_b32 v235, a11
    v_accvgpr_read_b32 v236, a24
    v_accvgpr_read_b32 v237, a25
    v_cvt_pk_bf16_f32 v232, v232, v233
    v_accvgpr_read_b32 v238, a26
    v_accvgpr_read_b32 v239, a27
    s_waitcnt lgkmcnt(8)
    v_mfma_f32_32x32x16_bf16 v[200:215], v[8:11], a[224:227], v[200:215]
    ds_read_b128 v[16:19], v2 offset:544
    ds_read_b128 a[36:39], v3 offset:27904
    ds_read_b128 a[52:55], v3 offset:28928
    v_cvt_pk_bf16_f32 v233, v234, v235
    v_accvgpr_read_b32 v24, a40
    v_accvgpr_read_b32 v25, a41
    ds_write_b64 v1, v[232:233] offset:0
    v_mfma_f32_32x32x16_bf16 v[216:231], v[8:11], a[240:243], v[216:231]
    v_cvt_pk_bf16_f32 v236, v236, v237
    v_accvgpr_read_b32 v26, a42
    v_accvgpr_read_b32 v27, a43
    v_cvt_pk_bf16_f32 v237, v238, v239
    v_accvgpr_read_b32 v28, a56
    v_accvgpr_read_b32 v29, a57
    s_waitcnt lgkmcnt(4)
    v_mfma_f32_32x32x16_bf16 v[64:79], v[12:15], a[4:7], v[64:79]
    ds_read_b128 v[8:11], v2 offset:768
    ds_read_b128 a[68:71], v3 offset:29952
    ds_read_b128 a[84:87], v3 offset:30976
    ds_write_b64 v1, v[236:237] offset:1040
    v_cvt_pk_bf16_f32 v24, v24, v25
    v_accvgpr_read_b32 v30, a58
    v_accvgpr_read_b32 v31, a59
    v_mfma_f32_32x32x16_bf16 v[80:95], v[12:15], a[20:23], v[80:95]
    v_cvt_pk_bf16_f32 v25, v26, v27
    v_accvgpr_read_b32 v232, a72
    v_accvgpr_read_b32 v233, a73
    ds_write_b64 v1, v[24:25] offset:2080
    v_cvt_pk_bf16_f32 v28, v28, v29
    v_accvgpr_read_b32 v234, a74
    s_waitcnt lgkmcnt(6)
    v_mfma_f32_32x32x16_bf16 v[64:79], v[16:19], a[36:39], v[64:79]
    ds_read_b128 v[12:15], v2 offset:800
    ds_read_b128 a[100:103], v3 offset:32000
    ds_read_b128 a[116:119], v3 offset:33024
    v_accvgpr_read_b32 v235, a75
    v_cvt_pk_bf16_f32 v29, v30, v31
    v_accvgpr_read_b32 v236, a88
    v_accvgpr_read_b32 v237, a89
    v_mfma_f32_32x32x16_bf16 v[80:95], v[16:19], a[52:55], v[80:95]
    ds_write_b64 v1, v[28:29] offset:3120
    v_cvt_pk_bf16_f32 v232, v232, v233
    v_accvgpr_read_b32 v238, a90
    v_accvgpr_read_b32 v239, a91
    v_cvt_pk_bf16_f32 v233, v234, v235
    v_accvgpr_read_b32 v24, a104
    s_waitcnt lgkmcnt(6)
    v_mfma_f32_32x32x16_bf16 v[64:79], v[8:11], a[68:71], v[64:79]
    ds_read_b128 v[16:19], v2 offset:576
    ds_read_b128 a[132:135], v3 offset:17664
    ds_read_b128 a[148:151], v3 offset:18688
    v_accvgpr_read_b32 v25, a105
    ds_write_b64 v1, v[232:233] offset:4160
    v_cvt_pk_bf16_f32 v236, v236, v237
    v_accvgpr_read_b32 v26, a106
    v_mfma_f32_32x32x16_bf16 v[80:95], v[8:11], a[84:87], v[80:95]
    v_accvgpr_read_b32 v27, a107
    v_cvt_pk_bf16_f32 v237, v238, v239
    v_accvgpr_read_b32 v28, a120
    v_accvgpr_read_b32 v29, a121
    ds_write_b64 v1, v[236:237] offset:5200
    v_cvt_pk_bf16_f32 v24, v24, v25
    s_waitcnt lgkmcnt(6)
    v_mfma_f32_32x32x16_bf16 v[64:79], v[12:15], a[100:103], v[64:79]
    ds_read_b128 v[8:11], v2 offset:608
    ds_read_b128 a[164:167], v3 offset:19712
    ds_read_b128 a[180:183], v3 offset:20736
    v_accvgpr_read_b32 v30, a122
    v_accvgpr_read_b32 v31, a123
    v_cvt_pk_bf16_f32 v25, v26, v27
    v_accvgpr_read_b32 v232, a136
    v_mfma_f32_32x32x16_bf16 v[80:95], v[12:15], a[116:119], v[80:95]
    v_accvgpr_read_b32 v233, a137
    ds_write_b64 v1, v[24:25] offset:6240
    v_cvt_pk_bf16_f32 v28, v28, v29
    v_accvgpr_read_b32 v234, a138
    v_accvgpr_read_b32 v235, a139
    v_cvt_pk_bf16_f32 v29, v30, v31
    s_waitcnt lgkmcnt(6)
    v_mfma_f32_32x32x16_bf16 v[32:47], v[16:19], a[132:135], v[32:47]
    ds_read_b128 v[12:15], v2 offset:832
    ds_read_b128 a[196:199], v3 offset:21760
    ds_read_b128 a[212:215], v3 offset:22784
    v_accvgpr_read_b32 v236, a152
    v_accvgpr_read_b32 v237, a153
    ds_write_b64 v1, v[28:29] offset:7280
    v_cvt_pk_bf16_f32 v232, v232, v233
    v_mfma_f32_32x32x16_bf16 v[48:63], v[16:19], a[148:151], v[48:63]
    v_accvgpr_read_b32 v238, a154
    v_accvgpr_read_b32 v239, a155
    ds_write_b64 v1, v[116:117] offset:16640
    v_cvt_pk_bf16_f32 v233, v234, v235
    v_accvgpr_read_b32 v24, a168
    v_accvgpr_read_b32 v25, a169
    s_waitcnt lgkmcnt(6)
    v_mfma_f32_32x32x16_bf16 v[32:47], v[8:11], a[164:167], v[32:47]
    ds_read_b128 v[16:19], v2 offset:864
    ds_read_b128 a[228:231], v3 offset:23808
    ds_read_b128 a[244:247], v3 offset:24832
    ds_write_b64 v1, v[232:233] offset:8320
    v_cvt_pk_bf16_f32 v236, v236, v237
    v_accvgpr_read_b32 v26, a170
    v_mfma_f32_32x32x16_bf16 v[48:63], v[8:11], a[180:183], v[48:63]
    v_accvgpr_read_b32 v27, a171
    ds_write_b64 v1, v[124:125] offset:17680
    v_cvt_pk_bf16_f32 v237, v238, v239
    v_accvgpr_read_b32 v28, a184
    v_accvgpr_read_b32 v29, a185
    ds_write_b64 v1, v[236:237] offset:9360
    s_waitcnt lgkmcnt(8)
    v_mfma_f32_32x32x16_bf16 v[32:47], v[12:15], a[196:199], v[32:47]
    ds_read_b128 v[8:11], v2 offset:640
    ds_read_b128 a[0:3], v3 offset:42240
    ds_read_b128 a[16:19], v3 offset:43264
    v_cvt_pk_bf16_f32 v24, v24, v25
    v_accvgpr_read_b32 v30, a186
    v_accvgpr_read_b32 v31, a187
    ds_write_b64 v1, v[132:133] offset:18720
    v_mfma_f32_32x32x16_bf16 v[48:63], v[12:15], a[212:215], v[48:63]
    v_cvt_pk_bf16_f32 v25, v26, v27
    v_accvgpr_read_b32 v232, a200
    v_accvgpr_read_b32 v233, a201
    ds_write_b64 v1, v[24:25] offset:10400
    v_cvt_pk_bf16_f32 v28, v28, v29
    v_accvgpr_read_b32 v234, a202
    s_waitcnt lgkmcnt(8)
    v_mfma_f32_32x32x16_bf16 v[32:47], v[16:19], a[228:231], v[32:47]
    ds_read_b128 v[12:15], v2 offset:672
    ds_read_b128 a[32:35], v3 offset:44288
    ds_read_b128 a[48:51], v3 offset:45312
    v_accvgpr_read_b32 v235, a203
    ds_write_b64 v1, v[140:141] offset:19760
    v_cvt_pk_bf16_f32 v29, v30, v31
    v_mfma_f32_32x32x16_bf16 v[48:63], v[16:19], a[244:247], v[48:63]
    v_accvgpr_read_b32 v236, a216
    v_accvgpr_read_b32 v237, a217
    ds_write_b64 v1, v[28:29] offset:11440
    v_cvt_pk_bf16_f32 v232, v232, v233
    v_accvgpr_read_b32 v238, a218
    v_accvgpr_read_b32 v239, a219
    s_waitcnt lgkmcnt(7)
    v_mfma_f32_32x32x16_bf16 v[200:215], v[8:11], a[0:3], v[200:215]
    ds_read_b128 v[16:19], v2 offset:896
    ds_read_b128 a[64:67], v3 offset:46336
    ds_read_b128 a[80:83], v3 offset:47360
    ds_write_b64 v1, v[148:149] offset:20800
    v_cvt_pk_bf16_f32 v233, v234, v235
    v_accvgpr_read_b32 v24, a232
    v_mfma_f32_32x32x16_bf16 v[216:231], v[8:11], a[16:19], v[216:231]
    v_accvgpr_read_b32 v25, a233
    ds_write_b64 v1, v[232:233] offset:12480
    v_cvt_pk_bf16_f32 v236, v236, v237
    v_accvgpr_read_b32 v26, a234
    v_accvgpr_read_b32 v27, a235
    ds_write_b64 v1, v[156:157] offset:21840
    s_waitcnt lgkmcnt(8)
    v_mfma_f32_32x32x16_bf16 v[200:215], v[12:15], a[32:35], v[200:215]
    ds_read_b128 v[8:11], v2 offset:928
    ds_read_b128 a[96:99], v3 offset:48384
    ds_read_b128 a[112:115], v3 offset:49408
    v_cvt_pk_bf16_f32 v237, v238, v239
    v_accvgpr_read_b32 v28, a248
    v_accvgpr_read_b32 v29, a249
    ds_write_b64 v1, v[236:237] offset:13520
    v_mfma_f32_32x32x16_bf16 v[216:231], v[12:15], a[48:51], v[216:231]
    v_cvt_pk_bf16_f32 v24, v24, v25
    v_accvgpr_read_b32 v30, a250
    v_accvgpr_read_b32 v31, a251
    ds_write_b64 v1, v[164:165] offset:22880
    v_cvt_pk_bf16_f32 v25, v26, v27
    ds_write_b64 v1, v[24:25] offset:14560
    s_waitcnt lgkmcnt(9)
    v_mfma_f32_32x32x16_bf16 v[200:215], v[16:19], a[64:67], v[200:215]
    ds_read_b128 v[12:15], v2 offset:704
    ds_read_b128 a[128:131], v3 offset:50432
    ds_read_b128 a[144:147], v3 offset:51456
    v_cvt_pk_bf16_f32 v28, v28, v29
    ds_write_b64 v1, v[172:173] offset:23920
    v_cvt_pk_bf16_f32 v29, v30, v31
    v_mfma_f32_32x32x16_bf16 v[216:231], v[16:19], a[80:83], v[216:231]
    ds_write_b64 v1, v[28:29] offset:15600
    ds_write_b64 v1, v[180:181] offset:24960
    s_waitcnt lgkmcnt(9)
    v_mfma_f32_32x32x16_bf16 v[200:215], v[8:11], a[96:99], v[200:215]
    ds_read_b128 v[16:19], v2 offset:736
    ds_read_b128 a[160:163], v3 offset:52480
    ds_read_b128 a[176:179], v3 offset:53504
    v_mfma_f32_32x32x16_bf16 v[216:231], v[8:11], a[112:115], v[216:231]
    s_waitcnt lgkmcnt(6)
    v_mfma_f32_32x32x16_bf16 v[96:111], v[12:15], a[128:131], v[96:111]
    ds_read_b128 v[8:11], v2 offset:960
    ds_read_b128 a[192:195], v3 offset:54528
    ds_read_b128 a[208:211], v3 offset:55552
    v_mfma_f32_32x32x16_bf16 v[184:199], v[12:15], a[144:147], v[184:199]
    s_waitcnt lgkmcnt(3)
    v_mfma_f32_32x32x16_bf16 v[96:111], v[16:19], a[160:163], v[96:111]
    ds_read_b128 v[12:15], v2 offset:992
    ds_read_b128 a[224:227], v3 offset:56576
    ds_read_b128 a[240:243], v3 offset:57600
    v_mfma_f32_32x32x16_bf16 v[184:199], v[16:19], a[176:179], v[184:199]
    v_accvgpr_read_b32 v232, a12
    v_accvgpr_read_b32 v233, a13
    v_accvgpr_read_b32 v234, a14
    v_accvgpr_read_b32 v235, a15
    v_accvgpr_read_b32 v236, a28
    v_accvgpr_read_b32 v237, a29
    v_cvt_pk_bf16_f32 v232, v232, v233
    v_accvgpr_read_b32 v238, a30
    s_waitcnt lgkmcnt(3)
    v_mfma_f32_32x32x16_bf16 v[96:111], v[8:11], a[192:195], v[96:111]
    ds_read_b128 v[16:19], v2 offset:128
    v_accvgpr_read_b32 v239, a31
    v_cvt_pk_bf16_f32 v233, v234, v235
    v_accvgpr_read_b32 v24, a44
    v_accvgpr_read_b32 v25, a45
    ds_write_b64 v1, v[232:233] offset:512
    v_cvt_pk_bf16_f32 v236, v236, v237
    v_accvgpr_read_b32 v26, a46
    v_mfma_f32_32x32x16_bf16 v[184:199], v[8:11], a[208:211], v[184:199]
    v_accvgpr_read_b32 v27, a47
    v_cvt_pk_bf16_f32 v237, v238, v239
    v_accvgpr_read_b32 v28, a60
    v_accvgpr_read_b32 v29, a61
    ds_write_b64 v1, v[236:237] offset:1552
    v_cvt_pk_bf16_f32 v24, v24, v25
    v_accvgpr_read_b32 v30, a62
    s_waitcnt lgkmcnt(3)
    v_mfma_f32_32x32x16_bf16 v[96:111], v[12:15], a[224:227], v[96:111]
    ds_read_b128 v[8:11], v2 offset:160
    v_accvgpr_read_b32 v31, a63
    v_cvt_pk_bf16_f32 v25, v26, v27
    v_accvgpr_read_b32 v232, a76
    v_accvgpr_read_b32 v233, a77
    ds_write_b64 v1, v[24:25] offset:2592
    v_cvt_pk_bf16_f32 v28, v28, v29
    v_accvgpr_read_b32 v234, a78
    v_mfma_f32_32x32x16_bf16 v[184:199], v[12:15], a[240:243], v[184:199]
    v_accvgpr_read_b32 v235, a79
    v_cvt_pk_bf16_f32 v29, v30, v31
    v_accvgpr_read_b32 v236, a92
    v_accvgpr_read_b32 v237, a93
    ds_write_b64 v1, v[28:29] offset:3632
    v_cvt_pk_bf16_f32 v232, v232, v233
    v_accvgpr_read_b32 v238, a94
    v_accvgpr_read_b32 v239, a95
    s_waitcnt lgkmcnt(5)
    v_mfma_f32_32x32x16_bf16 v[32:47], v[16:19], a[132:135], v[32:47]
    ds_read_b128 v[12:15], v2 offset:384
    v_cvt_pk_bf16_f32 v233, v234, v235
    v_accvgpr_read_b32 v24, a108
    v_accvgpr_read_b32 v25, a109
    ds_write_b64 v1, v[232:233] offset:4672
    v_cvt_pk_bf16_f32 v236, v236, v237
    v_accvgpr_read_b32 v26, a110
    v_accvgpr_read_b32 v27, a111
    v_mfma_f32_32x32x16_bf16 v[48:63], v[16:19], a[148:151], v[48:63]
    v_cvt_pk_bf16_f32 v237, v238, v239
    v_accvgpr_read_b32 v28, a124
    v_accvgpr_read_b32 v29, a125
    ds_write_b64 v1, v[236:237] offset:5712
    v_cvt_pk_bf16_f32 v24, v24, v25
    v_accvgpr_read_b32 v30, a126
    v_accvgpr_read_b32 v31, a127
    s_waitcnt lgkmcnt(5)
    v_mfma_f32_32x32x16_bf16 v[32:47], v[8:11], a[164:167], v[32:47]
    ds_read_b128 v[16:19], v2 offset:416
    v_cvt_pk_bf16_f32 v25, v26, v27
    v_accvgpr_read_b32 v232, a140
    v_accvgpr_read_b32 v233, a141
    ds_write_b64 v1, v[24:25] offset:6752
    v_cvt_pk_bf16_f32 v28, v28, v29
    v_accvgpr_read_b32 v234, a142
    v_accvgpr_read_b32 v235, a143
    v_mfma_f32_32x32x16_bf16 v[48:63], v[8:11], a[180:183], v[48:63]
    v_cvt_pk_bf16_f32 v29, v30, v31
    v_accvgpr_read_b32 v236, a156
    v_accvgpr_read_b32 v237, a157
    ds_write_b64 v1, v[28:29] offset:7792
    v_cvt_pk_bf16_f32 v232, v232, v233
    v_accvgpr_read_b32 v238, a158
    v_accvgpr_read_b32 v239, a159
    s_waitcnt lgkmcnt(5)
    v_mfma_f32_32x32x16_bf16 v[32:47], v[12:15], a[196:199], v[32:47]
    ds_read_b128 v[8:11], v2 offset:0
    ds_write_b64 v1, v[118:119] offset:17152
    v_cvt_pk_bf16_f32 v233, v234, v235
    v_accvgpr_read_b32 v24, a172
    v_accvgpr_read_b32 v25, a173
    ds_write_b64 v1, v[232:233] offset:8832
    v_cvt_pk_bf16_f32 v236, v236, v237
    v_accvgpr_read_b32 v26, a174
    v_mfma_f32_32x32x16_bf16 v[48:63], v[12:15], a[212:215], v[48:63]
    v_accvgpr_read_b32 v27, a175
    ds_write_b64 v1, v[126:127] offset:18192
    v_cvt_pk_bf16_f32 v237, v238, v239
    v_accvgpr_read_b32 v28, a188
    v_accvgpr_read_b32 v29, a189
    ds_write_b64 v1, v[236:237] offset:9872
    v_cvt_pk_bf16_f32 v24, v24, v25
    s_waitcnt lgkmcnt(7)
    v_mfma_f32_32x32x16_bf16 v[32:47], v[16:19], a[228:231], v[32:47]
    ds_read_b128 v[12:15], v2 offset:32
    v_accvgpr_read_b32 v30, a190
    v_accvgpr_read_b32 v31, a191
    ds_write_b64 v1, v[134:135] offset:19232
    v_cvt_pk_bf16_f32 v25, v26, v27
    v_accvgpr_read_b32 v232, a204
    v_accvgpr_read_b32 v233, a205
    ds_write_b64 v1, v[24:25] offset:10912
    v_mfma_f32_32x32x16_bf16 v[48:63], v[16:19], a[244:247], v[48:63]
    v_cvt_pk_bf16_f32 v28, v28, v29
    v_accvgpr_read_b32 v234, a206
    v_accvgpr_read_b32 v235, a207
    ds_write_b64 v1, v[142:143] offset:20272
    v_cvt_pk_bf16_f32 v29, v30, v31
    v_accvgpr_read_b32 v236, a220
    v_accvgpr_read_b32 v237, a221
    s_waitcnt lgkmcnt(8)
    v_mfma_f32_32x32x16_bf16 v[96:111], v[8:11], a[4:7], v[96:111]
    ds_read_b128 v[16:19], v2 offset:256
    ds_write_b64 v1, v[28:29] offset:11952
    v_cvt_pk_bf16_f32 v232, v232, v233
    v_accvgpr_read_b32 v238, a222
    v_accvgpr_read_b32 v239, a223
    ds_write_b64 v1, v[150:151] offset:21312
    v_cvt_pk_bf16_f32 v233, v234, v235
    v_accvgpr_read_b32 v24, a236
    v_mfma_f32_32x32x16_bf16 v[184:199], v[8:11], a[20:23], v[184:199]
    v_accvgpr_read_b32 v25, a237
    ds_write_b64 v1, v[232:233] offset:12992
    v_cvt_pk_bf16_f32 v236, v236, v237
    v_accvgpr_read_b32 v26, a238
    v_accvgpr_read_b32 v27, a239
    ds_write_b64 v1, v[158:159] offset:22352
    v_cvt_pk_bf16_f32 v237, v238, v239
    s_waitcnt lgkmcnt(8)
    v_mfma_f32_32x32x16_bf16 v[96:111], v[12:15], a[36:39], v[96:111]
    ds_read_b128 v[8:11], v2 offset:288
    v_accvgpr_read_b32 v28, a252
    v_accvgpr_read_b32 v29, a253
    ds_write_b64 v1, v[236:237] offset:14032
    v_cvt_pk_bf16_f32 v24, v24, v25
    v_accvgpr_read_b32 v30, a254
    v_accvgpr_read_b32 v31, a255
    ds_write_b64 v1, v[166:167] offset:23392
    v_cvt_pk_bf16_f32 v25, v26, v27
    v_mfma_f32_32x32x16_bf16 v[184:199], v[12:15], a[52:55], v[184:199]
    ds_write_b64 v1, v[24:25] offset:15072
    v_cvt_pk_bf16_f32 v28, v28, v29
    ds_write_b64 v1, v[174:175] offset:24432
    v_cvt_pk_bf16_f32 v29, v30, v31
    ds_write_b64 v1, v[28:29] offset:16112
    ds_write_b64 v1, v[182:183] offset:25472
    s_waitcnt lgkmcnt(11)
    v_mfma_f32_32x32x16_bf16 v[96:111], v[16:19], a[68:71], v[96:111]
    ds_read_b128 v[12:15], v2 offset:704
    ds_read_b128 v[240:243], v5 offset:4608
    ds_read_b128 v[244:247], v5 offset:4640
    ds_read_b128 v[248:251], v5 offset:4672
    ds_read_b32 v252, v5 offset:4704
    s_waitcnt lgkmcnt(0)
    v_mfma_f32_32x32x16_bf16 v[184:199], v[16:19], a[84:87], v[184:199]
    v_add_u32 v240, v240, v4
    v_add_u32 v241, v241, v4
    v_add_u32 v242, v242, v4
    v_add_u32 v243, v243, v4
    v_add_u32 v244, v244, v4
    v_add_u32 v245, v245, v4
    s_waitcnt lgkmcnt(11)
    v_mfma_f32_32x32x16_bf16 v[96:111], v[8:11], a[100:103], v[96:111]
    ds_read_b128 v[16:19], v2 offset:736
    v_add_u32 v246, v246, v4
    v_add_u32 v247, v247, v4
    v_add_u32 v248, v248, v4
    v_add_u32 v249, v249, v4
    v_add_u32 v250, v250, v4
    v_add_u32 v251, v251, v4
    v_mfma_f32_32x32x16_bf16 v[184:199], v[8:11], a[116:119], v[184:199]
    v_add_u32 v252, v252, v4
    s_waitcnt lgkmcnt(5)
    v_mfma_f32_32x32x16_bf16 v[32:47], v[12:15], a[132:135], v[32:47]
    ds_read_b128 v[8:11], v2 offset:960
    v_mfma_f32_32x32x16_bf16 v[48:63], v[12:15], a[148:151], v[48:63]
    s_waitcnt lgkmcnt(1)
    v_mfma_f32_32x32x16_bf16 v[32:47], v[16:19], a[164:167], v[32:47]
    ds_read_b128 v[12:15], v2 offset:992
    v_mfma_f32_32x32x16_bf16 v[48:63], v[16:19], a[180:183], v[48:63]
    s_waitcnt lgkmcnt(1)
    v_mfma_f32_32x32x16_bf16 v[32:47], v[8:11], a[196:199], v[32:47]
    ds_read_b128 v[16:19], v2 offset:192
    v_mfma_f32_32x32x16_bf16 v[48:63], v[8:11], a[212:215], v[48:63]
    s_waitcnt lgkmcnt(1)
    v_mfma_f32_32x32x16_bf16 v[32:47], v[12:15], a[228:231], v[32:47]
    ds_read_b128 v[8:11], v2 offset:224
    v_mfma_f32_32x32x16_bf16 v[48:63], v[12:15], a[244:247], v[48:63]
    s_waitcnt lgkmcnt(1)
    v_mfma_f32_32x32x16_bf16 v[64:79], v[16:19], a[0:3], v[64:79]
    ds_read_b128 v[12:15], v2 offset:448
    v_mfma_f32_32x32x16_bf16 v[80:95], v[16:19], a[16:19], v[80:95]
    s_nop 7
    v_mul_f32 v112, 0xbfb8aa3b, v32
    v_mul_f32 v113, 0xbfb8aa3b, v33
    v_mul_f32 v114, 0xbfb8aa3b, v34
    v_mul_f32 v115, 0xbfb8aa3b, v35
    v_mul_f32 v116, 0xbfb8aa3b, v36
    v_mul_f32 v117, 0xbfb8aa3b, v37
    v_mul_f32 v118, 0xbfb8aa3b, v38
    s_waitcnt lgkmcnt(1)
    v_mfma_f32_32x32x16_bf16 v[64:79], v[8:11], a[32:35], v[64:79]
    ds_read_b128 v[16:19], v2 offset:480
    v_mul_f32 v119, 0xbfb8aa3b, v39
    v_mul_f32 v120, 0xbfb8aa3b, v40
    v_mul_f32 v121, 0xbfb8aa3b, v41
    v_mul_f32 v122, 0xbfb8aa3b, v42
    v_mul_f32 v123, 0xbfb8aa3b, v43
    v_mul_f32 v124, 0xbfb8aa3b, v44
    v_exp_f32 v112, v112
    v_mfma_f32_32x32x16_bf16 v[80:95], v[8:11], a[48:51], v[80:95]
    v_exp_f32 v113, v113
    v_exp_f32 v114, v114
    v_exp_f32 v115, v115
    v_exp_f32 v116, v116
    s_waitcnt lgkmcnt(1)
    v_mfma_f32_32x32x16_bf16 v[64:79], v[12:15], a[64:67], v[64:79]
    ds_read_b128 v[8:11], v2 offset:640
    v_exp_f32 v117, v117
    v_exp_f32 v118, v118
    v_exp_f32 v119, v119
    v_exp_f32 v120, v120
    v_mfma_f32_32x32x16_bf16 v[80:95], v[12:15], a[80:83], v[80:95]
    v_exp_f32 v121, v121
    v_exp_f32 v122, v122
    v_exp_f32 v123, v123
    v_exp_f32 v124, v124
    s_waitcnt lgkmcnt(1)
    v_mfma_f32_32x32x16_bf16 v[64:79], v[16:19], a[96:99], v[64:79]
    ds_read_b128 v[12:15], v2 offset:672
    v_add_f32 v112, 1.0, v112
    v_add_f32 v113, 1.0, v113
    v_add_f32 v114, 1.0, v114
    v_add_f32 v115, 1.0, v115
    v_add_f32 v116, 1.0, v116
    v_add_f32 v117, 1.0, v117
    v_add_f32 v118, 1.0, v118
    v_mfma_f32_32x32x16_bf16 v[80:95], v[16:19], a[112:115], v[80:95]
    v_add_f32 v119, 1.0, v119
    v_add_f32 v120, 1.0, v120
    v_add_f32 v121, 1.0, v121
    v_add_f32 v122, 1.0, v122
    v_add_f32 v123, 1.0, v123
    v_add_f32 v124, 1.0, v124
    v_rcp_f32 v112, v112
    s_waitcnt lgkmcnt(1)
    v_mfma_f32_32x32x16_bf16 v[64:79], v[8:11], a[128:131], v[64:79]
    ds_read_b128 v[16:19], v2 offset:896
    v_rcp_f32 v113, v113
    v_rcp_f32 v114, v114
    v_rcp_f32 v115, v115
    v_rcp_f32 v116, v116
    v_mfma_f32_32x32x16_bf16 v[80:95], v[8:11], a[144:147], v[80:95]
    v_rcp_f32 v117, v117
    v_rcp_f32 v118, v118
    v_rcp_f32 v119, v119
    v_rcp_f32 v120, v120
    s_waitcnt lgkmcnt(1)
    v_mfma_f32_32x32x16_bf16 v[64:79], v[12:15], a[160:163], v[64:79]
    ds_read_b128 v[8:11], v2 offset:928
    v_rcp_f32 v121, v121
    v_rcp_f32 v122, v122
    v_rcp_f32 v123, v123
    v_rcp_f32 v124, v124
    v_mfma_f32_32x32x16_bf16 v[80:95], v[12:15], a[176:179], v[80:95]
    v_mul_f32 v128, 0xbfb8aa3b, v48
    v_mul_f32 v129, 0xbfb8aa3b, v49
    v_mul_f32 v130, 0xbfb8aa3b, v50
    v_mul_f32 v131, 0xbfb8aa3b, v51
    v_mul_f32 v132, 0xbfb8aa3b, v52
    v_mul_f32 v133, 0xbfb8aa3b, v53
    v_mul_f32 v134, 0xbfb8aa3b, v54
    s_waitcnt lgkmcnt(1)
    v_mfma_f32_32x32x16_bf16 v[64:79], v[16:19], a[192:195], v[64:79]
    ds_read_b128 v[12:15], v2 offset:576
    v_mul_f32 v135, 0xbfb8aa3b, v55
    v_mul_f32 v136, 0xbfb8aa3b, v56
    v_mul_f32 v137, 0xbfb8aa3b, v57
    v_mul_f32 v138, 0xbfb8aa3b, v58
    v_mul_f32 v139, 0xbfb8aa3b, v59
    v_mul_f32 v140, 0xbfb8aa3b, v60
    v_exp_f32 v128, v128
    v_mfma_f32_32x32x16_bf16 v[80:95], v[16:19], a[208:211], v[80:95]
    v_exp_f32 v129, v129
    v_exp_f32 v130, v130
    v_exp_f32 v131, v131
    v_exp_f32 v132, v132
    s_waitcnt lgkmcnt(1)
    v_mfma_f32_32x32x16_bf16 v[64:79], v[8:11], a[224:227], v[64:79]
    ds_read_b128 v[16:19], v2 offset:608
    v_exp_f32 v133, v133
    v_exp_f32 v134, v134
    v_exp_f32 v135, v135
    v_exp_f32 v136, v136
    v_mfma_f32_32x32x16_bf16 v[80:95], v[8:11], a[240:243], v[80:95]
    v_exp_f32 v137, v137
    v_exp_f32 v138, v138
    v_exp_f32 v139, v139
    v_exp_f32 v140, v140
    s_waitcnt lgkmcnt(1)
    v_mfma_f32_32x32x16_bf16 v[96:111], v[12:15], a[0:3], v[96:111]
    ds_read_b128 v[8:11], v2 offset:832
    v_add_f32 v128, 1.0, v128
    v_add_f32 v129, 1.0, v129
    v_add_f32 v130, 1.0, v130
    v_add_f32 v131, 1.0, v131
    v_add_f32 v132, 1.0, v132
    v_add_f32 v133, 1.0, v133
    v_add_f32 v134, 1.0, v134
    v_mfma_f32_32x32x16_bf16 v[184:199], v[12:15], a[16:19], v[184:199]
    v_add_f32 v135, 1.0, v135
    v_add_f32 v136, 1.0, v136
    v_add_f32 v137, 1.0, v137
    v_add_f32 v138, 1.0, v138
    v_add_f32 v139, 1.0, v139
    v_add_f32 v140, 1.0, v140
    v_rcp_f32 v128, v128
    s_waitcnt lgkmcnt(1)
    v_mfma_f32_32x32x16_bf16 v[96:111], v[16:19], a[32:35], v[96:111]
    ds_read_b128 v[12:15], v2 offset:864
    v_rcp_f32 v129, v129
    v_rcp_f32 v130, v130
    v_rcp_f32 v131, v131
    v_rcp_f32 v132, v132
    v_mfma_f32_32x32x16_bf16 v[184:199], v[16:19], a[48:51], v[184:199]
    v_rcp_f32 v133, v133
    v_rcp_f32 v134, v134
    v_rcp_f32 v135, v135
    v_rcp_f32 v136, v136
    s_waitcnt lgkmcnt(1)
    v_mfma_f32_32x32x16_bf16 v[96:111], v[8:11], a[64:67], v[96:111]
    ds_read_b128 v[16:19], v2 offset:64
    v_rcp_f32 v137, v137
    v_rcp_f32 v138, v138
    v_rcp_f32 v139, v139
    v_rcp_f32 v140, v140
    v_mfma_f32_32x32x16_bf16 v[184:199], v[8:11], a[80:83], v[184:199]
    v_cvt_pk_bf16_f32 v232, v32, v48
    buffer_store_dword v232, v240, s[12:15], 0 offen sc1
    v_cvt_pk_bf16_f32 v233, v33, v49
    buffer_store_dword v233, v241, s[12:15], 0 offen sc1
    v_cvt_pk_bf16_f32 v234, v34, v50
    buffer_store_dword v234, v242, s[12:15], 0 offen sc1
    v_cvt_pk_bf16_f32 v235, v35, v51
    s_waitcnt lgkmcnt(1)
    v_mfma_f32_32x32x16_bf16 v[96:111], v[12:15], a[96:99], v[96:111]
    ds_read_b128 v[8:11], v2 offset:96
    buffer_store_dword v235, v243, s[12:15], 0 offen sc1
    v_cvt_pk_bf16_f32 v236, v36, v52
    buffer_store_dword v236, v244, s[12:15], 0 offen sc1
    v_cvt_pk_bf16_f32 v237, v37, v53
    buffer_store_dword v237, v245, s[12:15], 0 offen sc1
    v_cvt_pk_bf16_f32 v238, v38, v54
    v_mfma_f32_32x32x16_bf16 v[184:199], v[12:15], a[112:115], v[184:199]
    buffer_store_dword v238, v246, s[12:15], 0 offen sc1
    v_cvt_pk_bf16_f32 v239, v39, v55
    buffer_store_dword v239, v247, s[12:15], 0 offen sc1
    v_cvt_pk_bf16_f32 v232, v40, v56
    buffer_store_dword v232, v248, s[12:15], 0 offen sc1
    v_cvt_pk_bf16_f32 v233, v41, v57
    buffer_store_dword v233, v249, s[12:15], 0 offen sc1
    s_waitcnt lgkmcnt(1)
    v_mfma_f32_32x32x16_bf16 v[200:215], v[16:19], a[128:131], v[200:215]
    ds_read_b128 v[12:15], v2 offset:320
    v_cvt_pk_bf16_f32 v234, v42, v58
    buffer_store_dword v234, v250, s[12:15], 0 offen sc1
    v_cvt_pk_bf16_f32 v235, v43, v59
    buffer_store_dword v235, v251, s[12:15], 0 offen sc1
    v_cvt_pk_bf16_f32 v236, v44, v60
    buffer_store_dword v236, v252, s[12:15], 0 offen sc1
    v_mfma_f32_32x32x16_bf16 v[216:231], v[16:19], a[144:147], v[216:231]
    v_mul_f32 v64, v64, v112
    v_mul_f32 v80, v80, v128
    v_cvt_pk_bf16_f32 v232, v64, v80
    buffer_store_dword v232, v240, s[12:15], 0 offen offset:128 sc1
    v_mul_f32 v65, v65, v113
    v_mul_f32 v81, v81, v129
    v_cvt_pk_bf16_f32 v233, v65, v81
    s_waitcnt lgkmcnt(1)
    v_mfma_f32_32x32x16_bf16 v[200:215], v[8:11], a[160:163], v[200:215]
    ds_read_b128 v[16:19], v2 offset:352
    buffer_store_dword v233, v241, s[12:15], 0 offen offset:128 sc1
    v_mul_f32 v66, v66, v114
    v_mul_f32 v82, v82, v130
    v_cvt_pk_bf16_f32 v234, v66, v82
    buffer_store_dword v234, v242, s[12:15], 0 offen offset:128 sc1
    v_mul_f32 v67, v67, v115
    v_mul_f32 v83, v83, v131
    v_mfma_f32_32x32x16_bf16 v[216:231], v[8:11], a[176:179], v[216:231]
    v_cvt_pk_bf16_f32 v235, v67, v83
    buffer_store_dword v235, v243, s[12:15], 0 offen offset:128 sc1
    v_mul_f32 v68, v68, v116
    v_mul_f32 v84, v84, v132
    v_cvt_pk_bf16_f32 v236, v68, v84
    buffer_store_dword v236, v244, s[12:15], 0 offen offset:128 sc1
    v_mul_f32 v69, v69, v117
    s_waitcnt lgkmcnt(1)
    v_mfma_f32_32x32x16_bf16 v[200:215], v[12:15], a[192:195], v[200:215]
    ds_read_b128 v[8:11], v2 offset:512
    v_mul_f32 v85, v85, v133
    v_cvt_pk_bf16_f32 v237, v69, v85
    buffer_store_dword v237, v245, s[12:15], 0 offen offset:128 sc1
    v_mul_f32 v70, v70, v118
    v_mul_f32 v86, v86, v134
    v_cvt_pk_bf16_f32 v238, v70, v86
    buffer_store_dword v238, v246, s[12:15], 0 offen offset:128 sc1
    v_mfma_f32_32x32x16_bf16 v[216:231], v[12:15], a[208:211], v[216:231]
    v_mul_f32 v71, v71, v119
    v_mul_f32 v87, v87, v135
    v_cvt_pk_bf16_f32 v239, v71, v87
    buffer_store_dword v239, v247, s[12:15], 0 offen offset:128 sc1
    v_mul_f32 v72, v72, v120
    v_mul_f32 v88, v88, v136
    v_cvt_pk_bf16_f32 v232, v72, v88
    s_waitcnt lgkmcnt(1)
    v_mfma_f32_32x32x16_bf16 v[200:215], v[16:19], a[224:227], v[200:215]
    ds_read_b128 v[12:15], v2 offset:544
    buffer_store_dword v232, v248, s[12:15], 0 offen offset:128 sc1
    v_mul_f32 v73, v73, v121
    v_mul_f32 v89, v89, v137
    v_cvt_pk_bf16_f32 v233, v73, v89
    buffer_store_dword v233, v249, s[12:15], 0 offen offset:128 sc1
    v_mul_f32 v74, v74, v122
    v_mul_f32 v90, v90, v138
    v_mfma_f32_32x32x16_bf16 v[216:231], v[16:19], a[240:243], v[216:231]
    v_cvt_pk_bf16_f32 v234, v74, v90
    buffer_store_dword v234, v250, s[12:15], 0 offen offset:128 sc1
    v_mul_f32 v75, v75, v123
    v_mul_f32 v91, v91, v139
    v_cvt_pk_bf16_f32 v235, v75, v91
    buffer_store_dword v235, v251, s[12:15], 0 offen offset:128 sc1
    v_mul_f32 v76, v76, v124
    s_waitcnt lgkmcnt(1)
    v_mfma_f32_32x32x16_bf16 v[200:215], v[8:11], a[4:7], v[200:215]
    ds_read_b128 v[16:19], v2 offset:768
    v_mul_f32 v92, v92, v140
    v_cvt_pk_bf16_f32 v236, v76, v92
    buffer_store_dword v236, v252, s[12:15], 0 offen offset:128 sc1
    v_mul_f32 v96, v96, v112
    v_mul_f32 v184, v184, v128
    v_cvt_pk_bf16_f32 v232, v96, v184
    v_mfma_f32_32x32x16_bf16 v[216:231], v[8:11], a[20:23], v[216:231]
    buffer_store_dword v232, v240, s[12:15], 0 offen offset:256 sc1
    v_mul_f32 v97, v97, v113
    v_mul_f32 v185, v185, v129
    v_cvt_pk_bf16_f32 v233, v97, v185
    buffer_store_dword v233, v241, s[12:15], 0 offen offset:256 sc1
    v_mul_f32 v98, v98, v114
    v_mul_f32 v186, v186, v130
    s_waitcnt lgkmcnt(1)
    v_mfma_f32_32x32x16_bf16 v[200:215], v[12:15], a[36:39], v[200:215]
    ds_read_b128 v[8:11], v2 offset:800
    v_cvt_pk_bf16_f32 v234, v98, v186
    buffer_store_dword v234, v242, s[12:15], 0 offen offset:256 sc1
    v_mul_f32 v99, v99, v115
    v_mul_f32 v187, v187, v131
    v_cvt_pk_bf16_f32 v235, v99, v187
    buffer_store_dword v235, v243, s[12:15], 0 offen offset:256 sc1
    v_mfma_f32_32x32x16_bf16 v[216:231], v[12:15], a[52:55], v[216:231]
    v_mul_f32 v100, v100, v116
    v_mul_f32 v188, v188, v132
    v_cvt_pk_bf16_f32 v236, v100, v188
    buffer_store_dword v236, v244, s[12:15], 0 offen offset:256 sc1
    v_mul_f32 v101, v101, v117
    v_mul_f32 v189, v189, v133
    v_cvt_pk_bf16_f32 v237, v101, v189
    s_waitcnt lgkmcnt(1)
    v_mfma_f32_32x32x16_bf16 v[200:215], v[16:19], a[68:71], v[200:215]
    buffer_store_dword v237, v245, s[12:15], 0 offen offset:256 sc1
    v_mul_f32 v102, v102, v118
    v_mul_f32 v190, v190, v134
    v_cvt_pk_bf16_f32 v238, v102, v190
    buffer_store_dword v238, v246, s[12:15], 0 offen offset:256 sc1
    v_mul_f32 v103, v103, v119
    v_mul_f32 v191, v191, v135
    v_cvt_pk_bf16_f32 v239, v103, v191
    v_mfma_f32_32x32x16_bf16 v[216:231], v[16:19], a[84:87], v[216:231]
    buffer_store_dword v239, v247, s[12:15], 0 offen offset:256 sc1
    v_mul_f32 v104, v104, v120
    v_mul_f32 v192, v192, v136
    v_cvt_pk_bf16_f32 v232, v104, v192
    buffer_store_dword v232, v248, s[12:15], 0 offen offset:256 sc1
    v_mul_f32 v105, v105, v121
    v_mul_f32 v193, v193, v137
    s_waitcnt lgkmcnt(0)
    v_mfma_f32_32x32x16_bf16 v[200:215], v[8:11], a[100:103], v[200:215]
    v_cvt_pk_bf16_f32 v233, v105, v193
    buffer_store_dword v233, v249, s[12:15], 0 offen offset:256 sc1
    v_mul_f32 v106, v106, v122
    v_mul_f32 v194, v194, v138
    v_cvt_pk_bf16_f32 v234, v106, v194
    buffer_store_dword v234, v250, s[12:15], 0 offen offset:256 sc1
    v_mul_f32 v107, v107, v123
    v_mfma_f32_32x32x16_bf16 v[216:231], v[8:11], a[116:119], v[216:231]
    v_mul_f32 v195, v195, v139
    v_cvt_pk_bf16_f32 v235, v107, v195
    buffer_store_dword v235, v251, s[12:15], 0 offen offset:256 sc1
    v_mul_f32 v108, v108, v124
    v_mul_f32 v196, v196, v140
    v_cvt_pk_bf16_f32 v236, v108, v196
    buffer_store_dword v236, v252, s[12:15], 0 offen offset:256 sc1
    s_nop 11
    v_mul_f32 v200, v200, v112
    v_mul_f32 v216, v216, v128
    v_cvt_pk_bf16_f32 v232, v200, v216
    buffer_store_dword v232, v240, s[12:15], 0 offen offset:384 sc1
    v_mul_f32 v201, v201, v113
    v_mul_f32 v217, v217, v129
    v_cvt_pk_bf16_f32 v233, v201, v217
    buffer_store_dword v233, v241, s[12:15], 0 offen offset:384 sc1
    v_mul_f32 v202, v202, v114
    v_mul_f32 v218, v218, v130
    v_cvt_pk_bf16_f32 v234, v202, v218
    buffer_store_dword v234, v242, s[12:15], 0 offen offset:384 sc1
    v_mul_f32 v203, v203, v115
    v_mul_f32 v219, v219, v131
    v_cvt_pk_bf16_f32 v235, v203, v219
    buffer_store_dword v235, v243, s[12:15], 0 offen offset:384 sc1
    v_mul_f32 v204, v204, v116
    v_mul_f32 v220, v220, v132
    v_cvt_pk_bf16_f32 v236, v204, v220
    buffer_store_dword v236, v244, s[12:15], 0 offen offset:384 sc1
    v_mul_f32 v205, v205, v117
    v_mul_f32 v221, v221, v133
    v_cvt_pk_bf16_f32 v237, v205, v221
    buffer_store_dword v237, v245, s[12:15], 0 offen offset:384 sc1
    v_mul_f32 v206, v206, v118
    v_mul_f32 v222, v222, v134
    v_cvt_pk_bf16_f32 v238, v206, v222
    buffer_store_dword v238, v246, s[12:15], 0 offen offset:384 sc1
    v_mul_f32 v207, v207, v119
    v_mul_f32 v223, v223, v135
    v_cvt_pk_bf16_f32 v239, v207, v223
    buffer_store_dword v239, v247, s[12:15], 0 offen offset:384 sc1
    v_mul_f32 v208, v208, v120
    v_mul_f32 v224, v224, v136
    v_cvt_pk_bf16_f32 v232, v208, v224
    buffer_store_dword v232, v248, s[12:15], 0 offen offset:384 sc1
    v_mul_f32 v209, v209, v121
    v_mul_f32 v225, v225, v137
    v_cvt_pk_bf16_f32 v233, v209, v225
    buffer_store_dword v233, v249, s[12:15], 0 offen offset:384 sc1
    v_mul_f32 v210, v210, v122
    v_mul_f32 v226, v226, v138
    v_cvt_pk_bf16_f32 v234, v210, v226
    buffer_store_dword v234, v250, s[12:15], 0 offen offset:384 sc1
    v_mul_f32 v211, v211, v123
    v_mul_f32 v227, v227, v139
    v_cvt_pk_bf16_f32 v235, v211, v227
    buffer_store_dword v235, v251, s[12:15], 0 offen offset:384 sc1
    v_mul_f32 v212, v212, v124
    v_mul_f32 v228, v228, v140
    v_cvt_pk_bf16_f32 v236, v212, v228
    buffer_store_dword v236, v252, s[12:15], 0 offen offset:384 sc1
    s_endpgm
L_ov_fail:
    v_mov_b32 v50, 1
    v_mov_b32 v51, 0
    ds_write_b32 v51, v50 offset:4480
    s_branch L_ov_done
L_s_slow:
    s_waitcnt lgkmcnt(0)
    s_mov_b64 exec, -1
    v_max3_u32 v90, v82, v83, v84
    v_max3_u32 v82, v90, v85, v86
    v_cvt_f32_u32 v91, v82
    v_readfirstlane_b32 s23, v82
    v_rcp_f32 v91, v91
    s_min_u32 s23, s23, 40
    s_mov_b64 exec, -1
    v_mul_f32 v91, 0x47800000, v91
    v_cvt_u32_f32 v91, v91
    v_add_u32 v91, 2, v91
    s_bfm_b64 s[78:79], s23, 0
    s_mov_b64 exec, -1
    v_mul_u32_u24 v92, v82, v91
    v_mul_u32_u24 v93, v83, v91
    v_mul_u32_u24 v94, v84, v91
    v_mul_u32_u24 v95, v85, v91
    v_mul_u32_u24 v96, v86, v91
    s_mov_b64 exec, -1
    v_mul_u32_u24 v98, v0, v92
    v_mul_u32_u24 v99, v0, v93
    v_mul_u32_u24 v100, v0, v94
    v_mul_u32_u24 v101, v0, v95
    v_mul_u32_u24 v102, v0, v96
    s_mov_b64 exec, -1
    v_add_u32 v92, v98, v92
    v_add_u32 v93, v99, v93
    v_add_u32 v94, v100, v94
    v_add_u32 v95, v101, v95
    v_add_u32 v96, v102, v96
    s_mov_b64 exec, -1
    v_lshrrev_b32 v98, 16, v98
    v_lshrrev_b32 v99, 16, v99
    v_lshrrev_b32 v100, 16, v100
    v_lshrrev_b32 v101, 16, v101
    v_lshrrev_b32 v102, 16, v102
    s_mov_b64 exec, -1
    v_lshrrev_b32 v92, 16, v92
    v_lshrrev_b32 v93, 16, v93
    v_lshrrev_b32 v94, 16, v94
    v_lshrrev_b32 v95, 16, v95
    v_lshrrev_b32 v96, 16, v96
    s_mov_b64 exec, -1
    v_cmp_gt_u32 s[24:25], v92, v98
    v_cmp_gt_u32 s[26:27], v93, v99
    v_cmp_gt_u32 s[28:29], v94, v100
    v_cmp_gt_u32 s[30:31], v95, v101
    v_cmp_gt_u32 s[32:33], v96, v102
    s_mul_i32 s81, s16, 848
    s_mov_b32 s80, s20
    s_mov_b64 exec, -1
    s_and_b64 s[24:25], s[24:25], s[78:79]
    s_and_b64 s[26:27], s[26:27], s[78:79]
    s_and_b64 s[28:29], s[28:29], s[78:79]
    s_and_b64 s[30:31], s[30:31], s[78:79]
    s_and_b64 s[32:33], s[32:33], s[78:79]
    v_mov_b32 v91, 0
    v_mov_b32 v3, s81
    s_mov_b64 exec, -1
    v_mbcnt_lo_u32_b32 v91, s24, v91
    v_mbcnt_hi_u32_b32 v91, s25, v91
    v_mbcnt_lo_u32_b32 v91, s26, v91
    v_mbcnt_hi_u32_b32 v91, s27, v91
    v_mbcnt_lo_u32_b32 v91, s28, v91
    v_mbcnt_hi_u32_b32 v91, s29, v91
    s_mov_b64 exec, -1
    v_mbcnt_lo_u32_b32 v91, s30, v91
    v_mbcnt_hi_u32_b32 v91, s31, v91
    v_mbcnt_lo_u32_b32 v91, s32, v91
    v_mbcnt_hi_u32_b32 v91, s33, v91
    v_lshl_add_u32 v91, v91, 2, s81
    s_mov_b64 exec, -1
    v_lshl_add_u32 v98, v98, 7, s80
    s_mov_b64 exec, s[24:25]
    ds_write_b32 v91, v98 offset:6016
    v_add_u32 v91, 4, v91
    s_add_u32 s80, s80, 5136
    s_mov_b64 exec, -1
    v_lshl_add_u32 v99, v99, 7, s80
    s_mov_b64 exec, s[26:27]
    ds_write_b32 v91, v99 offset:6016
    v_add_u32 v91, 4, v91
    s_add_u32 s80, s80, 5136
    s_mov_b64 exec, -1
    v_lshl_add_u32 v100, v100, 7, s80
    s_mov_b64 exec, s[28:29]
    ds_write_b32 v91, v100 offset:6016
    v_add_u32 v91, 4, v91
    s_add_u32 s80, s80, 5136
    s_mov_b64 exec, -1
    v_lshl_add_u32 v101, v101, 7, s80
    s_mov_b64 exec, s[30:31]
    ds_write_b32 v91, v101 offset:6016
    v_add_u32 v91, 4, v91
    s_add_u32 s80, s80, 5136
    s_mov_b64 exec, -1
    v_lshl_add_u32 v102, v102, 7, s80
    s_mov_b64 exec, s[32:33]
    ds_write_b32 v91, v102 offset:6016
    v_add_u32 v91, 4, v91
    s_branch L_s_done
L_to_slow:
    s_waitcnt lgkmcnt(0)
    v_lshrrev_b32 v50, 16, v39
    v_mov_b32 v51, 0
    ds_max_u32 v51, v50 offset:4484
    s_waitcnt lgkmcnt(0)
    s_barrier
    ds_read_b32 v50, v51 offset:4484
    s_waitcnt lgkmcnt(0)
    v_readfirstlane_b32 s84, v50
    s_barrier
    s_min_u32 s84, s84, 3200
    s_add_u32 s84, s84, 15
    s_lshr_b32 s84, s84, 4
    s_lshl_b32 s84, s84, 6
    s_mov_b32 s82, 1
    s_mov_b32 s83, 0
    s_branch L_batch
L_nomain:
    s_waitcnt vmcnt(0) lgkmcnt(0)
    v_and_b32 v49, 31, v0
    v_lshrrev_b32 v50, 5, v0
    v_lshlrev_b32 v44, 3, v49
    v_lshl_add_u32 v44, v50, 8, v44
    v_add_u32 v44, s20, v44
    v_min_u32 v45, 24, v49
    v_mul_u32_u24 v45, 1040, v45
    v_lshl_add_u32 v45, v50, 4, v45
    v_add_u32 v45, s20, v45
    v_lshlrev_b32 v46, 4, v0
    v_lshlrev_b32 v47, 2, v49
    s_lshl_b32 s78, s16, 7
    v_lshl_add_u32 v48, v50, 4, s78
    s_branch L_exit
L_next_batch:
    s_waitcnt vmcnt(0)
    s_add_u32 s83, s83, 1
    s_cmp_lt_u32 s83, s84
    s_cbranch_scc0 L_epi
L_batch:
    v_and_b32 v50, 3, v0
    v_cmp_eq_u32 vcc, 3, v50
    v_mov_b32 v58, 0
    v_mov_b32 v59, 0
    v_cndmask_b32 v54, 0, -1, vcc
    v_mov_b32 v55, v54
    v_mov_b32 v56, v54
    v_mov_b32 v57, v54
    v_lshl_add_u32 v51, v0, 4, s20
    v_mov_b32 v60, 0
    v_mov_b32 v61, 0
    v_lshlrev_b32 v52, 4, v35
    ds_write_b128 v52, v[58:61] offset:0
    v_cmp_gt_u32 vcc, 32, v35
    s_and_saveexec_b64 s[78:79], vcc
    ds_write_b128 v52, v[58:61] offset:4096
    s_mov_b64 exec, s[78:79]
    s_mul_i32 s80, s16, 192
    s_mul_i32 s81, s16, 848
    v_lshl_add_u32 v52, v0, 4, s80
    v_lshl_add_u32 v53, v0, 4, s81
    v_mov_b32 v62, 5888
    v_mov_b32 v63, 5888
    v_mov_b32 v64, 5888
    v_mov_b32 v65, 5888
    v_lshlrev_b32 v66, 4, v0
    s_lshl_b32 s80, s16, 7
    v_lshl_add_u32 v67, v0, 2, s80
    v_mov_b32 v68, 2147483632
    v_mov_b32 v43, 0
    s_mov_b64 exec, 0xfff
    ds_write_b128 v52, v[58:61] offset:5120
    s_mov_b32 exec_lo, -1
    s_mov_b32 exec_hi, 0x1fffff
    ds_write_b128 v53, v[62:65] offset:6016
    s_mov_b32 exec_hi, 0
    ds_write_b32 v67, v68 offset:4608
    s_mov_b32 exec_lo, 0xff
    ds_write_b128 v66, v[54:57] offset:5888
    s_mov_b64 exec, -1
    ds_write_b128 v51, v[54:57] offset:0
    ds_write_b128 v51, v[54:57] offset:1024
    ds_write_b128 v51, v[54:57] offset:2048
    ds_write_b128 v51, v[54:57] offset:3072
    ds_write_b128 v51, v[54:57] offset:4096
    ds_write_b128 v51, v[54:57] offset:5136
    ds_write_b128 v51, v[54:57] offset:6160
    ds_write_b128 v51, v[54:57] offset:7184
    ds_write_b128 v51, v[54:57] offset:8208
    ds_write_b128 v51, v[54:57] offset:9232
    ds_write_b128 v51, v[54:57] offset:10272
    ds_write_b128 v51, v[54:57] offset:11296
    ds_write_b128 v51, v[54:57] offset:12320
    ds_write_b128 v51, v[54:57] offset:13344
    ds_write_b128 v51, v[54:57] offset:14368
    ds_write_b128 v51, v[54:57] offset:15408
    ds_write_b128 v51, v[54:57] offset:16432
    ds_write_b128 v51, v[54:57] offset:17456
    ds_write_b128 v51, v[54:57] offset:18480
    ds_write_b128 v51, v[54:57] offset:19504
    ds_write_b128 v51, v[54:57] offset:20544
    ds_write_b128 v51, v[54:57] offset:21568
    ds_write_b128 v51, v[54:57] offset:22592
    ds_write_b128 v51, v[54:57] offset:23616
    ds_write_b128 v51, v[54:57] offset:24640
    v_mov_b32 v80, 1
    s_and_b32 s78, s83, 15
    v_lshrrev_b32 v70, 4, v35
    v_lshlrev_b32 v70, 6, v70
    s_lshl_b32 s79, s78, 2
    v_add_u32 v70, s79, v70
    buffer_load_dword v72, v70, s[8:11], s85 offen
    s_mul_i32 s78, s78, 12800
    s_lshr_b32 s79, s83, 6
    s_lshl_b32 s79, s79, 4
    s_bfe_u32 s80, s83, 0x20004
    s_cmp_eq_u32 s80, s16
    s_cselect_b32 s81, -1, 0
    s_waitcnt vmcnt(0)
    v_lshrrev_b32 v71, 16, v72
    v_and_b32 v72, 0xffff, v72
    v_add_u32 v72, s79, v72
    v_max_u32 v71, s79, v71
    v_subrev_u32 v71, s79, v71
    v_and_b32 v71, s81, v71
    v_lshl_or_b32 v72, v71, 16, v72
    v_mad_u32_u16 v49, v72, 4, v7
    v_cmpx_lt_u32_sdwa s[34:35], v6, v72 src0_sel:DWORD src1_sel:WORD_1
    buffer_load_dword v46, v49, s[8:11], s78 offen
    s_mov_b64 exec, -1
    s_mov_b64 s[36:37], 0
    s_mov_b64 s[38:39], 0
    s_mov_b64 s[40:41], 0
    s_mov_b64 s[42:43], 0
    s_waitcnt lgkmcnt(0)
    s_barrier
    s_lshl_b32 s78, s78, 1
    s_add_u32 s78, s78, 3200000
    s_mov_b64 exec, s[34:35]
    s_waitcnt vmcnt(0)
    v_lshrrev_b32 v47, 27, v46
    v_bfe_u32 v26, v46, 15, 12
    v_lshlrev_b32 v48, v47, v80
    v_lshlrev_b32 v49, 1, v49
    ds_add_rtn_u32 v48, v26, v48 offset:0
    buffer_load_dwordx2 v[44:45], v49, s[8:11], s78 offen
    s_branch L_a_done
L_k2_end:
    s_endpgm
.section .rodata,"a"
.p2align 6
.amdhsa_kernel sort_kernel
  .amdhsa_next_free_vgpr 72
  .amdhsa_next_free_sgpr 72
  .amdhsa_accum_offset 72
  .amdhsa_group_segment_fixed_size 0
  .amdhsa_kernarg_size 96
  .amdhsa_user_sgpr_count 2
  .amdhsa_user_sgpr_kernarg_segment_ptr 1
  .amdhsa_system_sgpr_workgroup_id_x 1
  .amdhsa_float_denorm_mode_32 3
.end_amdhsa_kernel
.p2align 6
.amdhsa_kernel main_kernel
  .amdhsa_next_free_vgpr 512
  .amdhsa_next_free_sgpr 102
  .amdhsa_accum_offset 256
  .amdhsa_group_segment_fixed_size 0
  .amdhsa_kernarg_size 96
  .amdhsa_user_sgpr_count 2
  .amdhsa_user_sgpr_kernarg_segment_ptr 1
  .amdhsa_system_sgpr_workgroup_id_x 1
  .amdhsa_float_denorm_mode_32 3
.end_amdhsa_kernel
```
